```python
import torch

def _softmax(x, axis=-1):
    return torch.softmax(x, dim=axis)
def _gelu(x):
    return torch.nn.functional.gelu(x, approximate="tanh")
def _silu(x):
    return torch.nn.functional.silu(x)
def _sigmoid(x):
    return torch.sigmoid(x)
def _layernorm(x, axis=-1, eps=1e-5):
    m = x.mean(dim=axis, keepdim=True)
    v = x.var(dim=axis, keepdim=True, unbiased=False)
    return (x - m) / torch.sqrt(v + eps)
def _scatter_add(tgt, idx, src, axis=0):
    return tgt.clone().index_add_(axis, idx, src)
def _segment_sum(src, seg, n):
    out = torch.zeros((n,) + src.shape[1:], dtype=src.dtype)
    return out.index_add_(0, seg, src)
def _pad(x, pw):
    flat = tuple(v for pair in reversed(pw) for v in pair)
    return torch.nn.functional.pad(x, flat)

kernel_name = 'concat_heads__gqa_block_cached__gqa_block_cached__near_ridge'

def setup_inputs():

    _w = (lambda a: (lambda t: t.to(torch.bfloat16) if t.is_floating_point() else t)(torch.as_tensor(a)))
    def _A_setup():
        B, Sq, D = 8, 64, 448
        Hq, Hkv, Sk, Dh = 16, 8, 64, 256
        assert Hq % Hkv == 0, (Hq, Hkv)
        return {
            "x": _w((lambda *s: torch.randn(*s, dtype=torch.bfloat16) * 0.8)(B, Sq, D)),
            "k_cache": _w((lambda *s: torch.randn(*s, dtype=torch.bfloat16) * 0.8)(B, Hkv, Sk, Dh)),
            "v_cache": _w((lambda *s: torch.randn(*s, dtype=torch.bfloat16) * 0.05)(B, Hkv, Sk, Dh)),
            "wq": _w((lambda *s: torch.randn(*s, dtype=torch.bfloat16) * 0.8)(D, Hq * Dh) * (D ** -0.5)),
            "wo": _w((lambda *s: torch.randn(*s, dtype=torch.bfloat16) * 0.05)(Hq * Dh, D) * ((Hq * Dh) ** -0.5)),
        }
    _A_in = _A_setup()

    def _B_setup():
        B, Sq, D = 8, 64, 448
        Hq, Hkv, Sk, Dh = 16, 8, 64, 256
        assert Hq % Hkv == 0, (Hq, Hkv)
        return {
            "x": _w((lambda *s: torch.randn(*s, dtype=torch.bfloat16) * 0.8)(B, Sq, D)),
            "k_cache": _w((lambda *s: torch.randn(*s, dtype=torch.bfloat16) * 0.8)(B, Hkv, Sk, Dh)),
            "v_cache": _w((lambda *s: torch.randn(*s, dtype=torch.bfloat16) * 0.05)(B, Hkv, Sk, Dh)),
            "wq": _w((lambda *s: torch.randn(*s, dtype=torch.bfloat16) * 0.8)(D, Hq * Dh) * (D ** -0.5)),
            "wo": _w((lambda *s: torch.randn(*s, dtype=torch.bfloat16) * 0.05)(Hq * Dh, D) * ((Hq * Dh) ** -0.5)),
        }
    _B_in = _B_setup()

    return {
        "A_x": _A_in["x"],
        "A_k_cache": _A_in["k_cache"],
        "A_v_cache": _A_in["v_cache"],
        "A_wq": _A_in["wq"],
        "A_wo": _A_in["wo"],
        "B_x": _B_in["x"],
        "B_k_cache": _B_in["k_cache"],
        "B_v_cache": _B_in["v_cache"],
        "B_wq": _B_in["wq"],
        "B_wo": _B_in["wo"],
    }

def reference(A_x, A_k_cache, A_v_cache, A_wq, A_wo, B_x, B_k_cache, B_v_cache, B_wq, B_wo):
    def _A_ref(x, k_cache, v_cache, wq, wo):
        B, Sq, D = x.shape
        Hq, Dh = 16, 256
        Hkv = k_cache.shape[1]
        rep = Hq // Hkv
        q = (lambda x, *d: x.permute(*d))((x @ wq).reshape(B, Sq, Hq, Dh), 0, 2, 1, 3)
        k = (lambda x, n, axis: torch.repeat_interleave(x, n, dim=axis))(k_cache, rep, axis=1)
        v = (lambda x, n, axis: torch.repeat_interleave(x, n, dim=axis))(v_cache, rep, axis=1)
        scores = torch.einsum("bhqd,bhkd->bhqk", q, k) * (Dh ** -0.5)
        p = _softmax(scores, axis=-1)
        o = torch.einsum("bhqk,bhkd->bhqd", p, v)
        return (lambda x, *d: x.permute(*d))(o, 0, 2, 1, 3).reshape(B, Sq, Hq * Dh) @ wo

    def _B_ref(x, k_cache, v_cache, wq, wo):
        B, Sq, D = x.shape
        Hq, Dh = 16, 256
        Hkv = k_cache.shape[1]
        rep = Hq // Hkv
        q = (lambda x, *d: x.permute(*d))((x @ wq).reshape(B, Sq, Hq, Dh), 0, 2, 1, 3)
        k = (lambda x, n, axis: torch.repeat_interleave(x, n, dim=axis))(k_cache, rep, axis=1)
        v = (lambda x, n, axis: torch.repeat_interleave(x, n, dim=axis))(v_cache, rep, axis=1)
        scores = torch.einsum("bhqd,bhkd->bhqk", q, k) * (Dh ** -0.5)
        p = _softmax(scores, axis=-1)
        o = torch.einsum("bhqk,bhkd->bhqd", p, v)
        return (lambda x, *d: x.permute(*d))(o, 0, 2, 1, 3).reshape(B, Sq, Hq * Dh) @ wo

    a = _A_ref(A_x, A_k_cache, A_v_cache, A_wq, A_wo)
    b = _B_ref(B_x, B_k_cache, B_v_cache, B_wq, B_wo)
    return torch.concatenate([a, b], axis=-1)
```

```asm
; @launch grid=(256,1,1) block=(512,1,1) lds=163840
.amdgcn_target "amdgcn-amd-amdhsa--gfx950"
.text
.globl concat_heads__gqa_block_cached__gqa_block_cached__near_ridge_kernel
.p2align 8
.type concat_heads__gqa_block_cached__gqa_block_cached__near_ridge_kernel,@function
concat_heads__gqa_block_cached__gqa_block_cached__near_ridge_kernel:
    s_cmp_ge_u32 s2, 256
    s_cbranch_scc1 L_done
    s_and_b32 s3, s2, 7
    s_lshr_b32 s5, s3, 2
    s_mul_i32 s11, s5, 40
    s_add_u32 s12, s0, s11
    s_addc_u32 s13, s1, 0
    s_load_dwordx8 s[16:23], s[12:13], 0
    s_load_dwordx2 s[24:25], s[12:13], 32
    s_load_dwordx4 s[28:31], s[0:1], 80
    s_load_dwordx2 s[26:27], s[0:1], 96
    v_lshrrev_b32 v1, 6, v0
    v_and_b32 v2, 63, v0
    v_readfirstlane_b32 s14, v1
    s_lshr_b32 s4, s2, 3
    s_and_b32 s6, s3, 3
    s_lshr_b32 s7, s4, 2
    s_and_b32 s8, s4, 3
    s_lshl2_add_u32 s9, s6, s8
    s_lshr_b32 s10, s9, 1
    s_lshl3_add_u32 s15, s5, s7
    s_cmp_ge_u32 s14, 4
    s_cbranch_scc1 L_loader
    s_setprio 2
    v_and_b32 v3, 15, v2
    v_lshrrev_b32 v4, 4, v2
    v_lshrrev_b32 v5, 2, v3
    v_and_b32 v6, 3, v2
    v_lshlrev_b32 v7, 3, v4
    v_add_u32 v7, v7, v5
    v_lshlrev_b32 v9, 9, v7
    v_lshlrev_b32 v8, 3, v6
    v_add_u32 v9, v9, v8
    v_xor_b32 v8, s14, v4
    v_and_b32 v8, 1, v8
    v_lshlrev_b32 v8, 2, v8
    s_lshr_b32 s32, s14, 1
    s_lshl_b32 s32, s32, 3
    v_add_u32 v8, s32, v8
    v_add_u32 v8, v8, v5
    v_lshlrev_b32 v8, 5, v8
    v_add_u32 v10, v9, v8
    v_xor_b32 v11, 32, v10
    v_xor_b32 v12, 64, v10
    v_xor_b32 v13, 96, v10
    v_lshlrev_b32 v9, 8, v7
    v_and_b32 v8, 1, v4
    v_lshlrev_b32 v8, 2, v8
    v_add_u32 v8, v8, v5
    s_lshl_b32 s32, s14, 1
    v_xor_b32 v8, s32, v8
    v_lshlrev_b32 v8, 5, v8
    v_add_u32 v9, v9, v8
    v_lshlrev_b32 v8, 3, v6
    v_add_u32 v21, v9, v8
    v_xor_b32 v22, 32, v21
    v_lshrrev_b32 v7, 1, v3
    v_xor_b32 v7, v7, v4
    v_lshlrev_b32 v7, 4, v7
    v_lshlrev_b32 v8, 7, v3
    v_add_u32 v7, v7, v8
    v_add_u32 v14, 32768, v7
    v_xor_b32 v15, 64, v14
    v_xor_b32 v7, v3, v4
    v_lshlrev_b32 v7, 4, v7
    v_lshlrev_b32 v8, 9, v3
    v_add_u32 v16, v7, v8
    v_xor_b32 v17, 64, v16
    v_xor_b32 v18, 128, v16
    v_xor_b32 v19, 192, v16
    v_lshrrev_b32 v7, 1, v4
    s_lshl_b32 s32, s14, 3
    v_or_b32 v7, s32, v7
    v_xor_b32 v7, v7, v3
    v_lshlrev_b32 v7, 4, v7
    v_lshlrev_b32 v8, 9, v3
    v_add_u32 v7, v7, v8
    v_and_b32 v8, 1, v4
    v_lshlrev_b32 v8, 3, v8
    v_add_u32 v7, v7, v8
    v_add_u32 v20, 40960, v7
    v_xor_b32 v3, 32, v20
    v_xor_b32 v5, 64, v20
    v_xor_b32 v6, 96, v20
    v_lshlrev_b32 v23, 4, v2
    v_and_b32 v7, 15, v2
    v_mul_u32_u24 v7, 1792, v7
    v_and_b32 v8, 1, v4
    v_lshlrev_b32 v8, 5, v8
    v_add_u32 v7, v7, v8
    v_lshrrev_b32 v8, 1, v4
    v_lshlrev_b32 v8, 4, v8
    v_add_u32 v24, v7, v8
    v_mov_b32 v64, 0
    v_mov_b32 v65, 0
    v_mov_b32 v66, 0
    v_mov_b32 v67, 0
    v_mov_b32 v68, 0
    v_mov_b32 v69, 0
    v_mov_b32 v70, 0
    v_mov_b32 v71, 0
    v_mov_b32 v72, 0
    v_mov_b32 v73, 0
    v_mov_b32 v74, 0
    v_mov_b32 v75, 0
    v_mov_b32 v76, 0
    v_mov_b32 v77, 0
    v_mov_b32 v78, 0
    v_mov_b32 v79, 0
    v_mov_b32 v80, 0
    v_mov_b32 v81, 0
    v_mov_b32 v82, 0
    v_mov_b32 v83, 0
    v_mov_b32 v84, 0
    v_mov_b32 v85, 0
    v_mov_b32 v86, 0
    v_mov_b32 v87, 0
    v_mov_b32 v88, 0
    v_mov_b32 v89, 0
    v_mov_b32 v90, 0
    v_mov_b32 v91, 0
    v_mov_b32 v92, 0
    v_mov_b32 v93, 0
    v_mov_b32 v94, 0
    v_mov_b32 v95, 0
    v_mov_b32 v96, 0
    v_mov_b32 v97, 0
    v_mov_b32 v98, 0
    v_mov_b32 v99, 0
    v_mov_b32 v100, 0
    v_mov_b32 v101, 0
    v_mov_b32 v102, 0
    v_mov_b32 v103, 0
    v_mov_b32 v104, 0
    v_mov_b32 v105, 0
    v_mov_b32 v106, 0
    v_mov_b32 v107, 0
    v_mov_b32 v108, 0
    v_mov_b32 v109, 0
    v_mov_b32 v110, 0
    v_mov_b32 v111, 0
    v_mov_b32 v112, 0
    v_mov_b32 v113, 0
    v_mov_b32 v114, 0
    v_mov_b32 v115, 0
    v_mov_b32 v116, 0
    v_mov_b32 v117, 0
    v_mov_b32 v118, 0
    v_mov_b32 v119, 0
    v_mov_b32 v120, 0
    v_mov_b32 v121, 0
    v_mov_b32 v122, 0
    v_mov_b32 v123, 0
    v_mov_b32 v124, 0
    v_mov_b32 v125, 0
    v_mov_b32 v126, 0
    v_mov_b32 v127, 0
    s_mov_b32 s32, 122880
    v_add_u32 v7, s32, v16
    v_add_u32 v8, s32, v17
    v_add_u32 v9, s32, v18
    v_add_u32 v25, s32, v19
    s_mov_b32 s46, 0x3db8aa3b
    s_waitcnt lgkmcnt(0)
    s_mov_b32 s52, s26
    s_and_b32 s53, s27, 0xffff
    s_mov_b32 s54, 12845056
    s_mov_b32 s55, 0x20000
    s_lshl2_add_u32 s33, s15, s6
    s_lshl2_add_u32 s33, s33, s8
    s_lshl_b32 s33, s33, 13
    s_lshl_b32 s32, s14, 11
    s_add_u32 s33, s33, s32
    s_lshl2_add_u32 s49, s15, s6
    s_lshl2_add_u32 s49, s49, s14
    s_lshl2_add_u32 s49, s49, s8
    s_lshl_b32 s49, s49, 7
    s_add_u32 s49, s49, 12582912
    s_lshl2_add_u32 s50, s15, s8
    s_lshl_b32 s50, s50, 16
    s_add_u32 s50, s50, 2097152
    s_lshl_b32 s32, s14, 10
    s_add_u32 s50, s50, s32
    s_lshl_b32 s32, s6, 12
    s_add_u32 s36, s50, s32
    s_lshl_b32 s32, s6, 14
    s_add_u32 s37, s50, s32
    s_lshl2_add_u32 s38, s8, s14
    s_cmp_ge_u32 s38, 14
    s_cselect_b32 s36, 0x7f000000, s36
    s_lshl2_add_u32 s40, s15, s8
    s_lshl2_add_u32 s40, s40, s14
    s_lshl_b32 s40, s40, 9
    s_add_u32 s40, s40, 12713984
    s_lshl_b32 s32, s6, 7
    s_add_u32 s41, s40, s32
    s_lshl_b32 s32, s7, 6
    s_lshl4_add_u32 s32, s6, s32
    s_mul_i32 s42, s32, 1792
    s_mul_i32 s32, s5, 896
    s_add_u32 s42, s42, s32
    s_lshl_b32 s32, s38, 6
    s_add_u32 s42, s42, s32
    s_lshr_b32 s32, s7, 2
    s_lshl_b32 s32, s32, 14
    s_xor_b32 s39, s32, 16384
    s_add_u32 s47, s32, 0
    s_add_u32 s48, s39, 0
    s_add_u32 s60, s6, 1
    s_and_b32 s60, s60, 3
    s_add_u32 s61, s6, 2
    s_and_b32 s61, s61, 3
    s_add_u32 s62, s6, 3
    s_and_b32 s62, s62, 3
    s_add_u32 s63, s6, 4
    s_and_b32 s63, s63, 3
    s_mov_b32 s56, s28
    s_and_b32 s57, s29, 0xffff
    s_mov_b32 s58, 917504
    s_mov_b32 s59, 0x20000
    s_mov_b32 s34, 0
    s_mov_b32 s35, 0
    v_add_u32 v26, s34, v10
    v_add_u32 v27, s34, v11
    v_add_u32 v28, s34, v12
    v_add_u32 v29, s34, v13
    v_add_u32 v30, s34, v14
    v_add_u32 v31, s34, v15
    s_barrier
    ds_read_b64_tr_b16 v[128:129], v26 offset:0
    ds_read_b64_tr_b16 v[130:131], v26 offset:2048
    ds_read_b128 v[144:147], v30 offset:0
    ds_read_b128 v[148:151], v30 offset:2048
    ds_read_b128 v[152:155], v30 offset:4096
    ds_read_b128 v[156:159], v30 offset:6144
    ds_read_b64_tr_b16 v[132:133], v27 offset:0
    ds_read_b64_tr_b16 v[134:135], v27 offset:2048
    ds_read_b64_tr_b16 v[136:137], v28 offset:0
    ds_read_b64_tr_b16 v[138:139], v28 offset:2048
    ds_read_b64_tr_b16 v[140:141], v29 offset:0
    ds_read_b64_tr_b16 v[142:143], v29 offset:2048
L_a1:
    s_waitcnt lgkmcnt(9)
    v_mfma_f32_16x16x32_bf16 v[64:67], v[128:131], v[144:147], v[64:67]
    ds_read_b64_tr_b16 v[160:161], v26 offset:16384
    s_waitcnt lgkmcnt(9)
    v_mfma_f32_16x16x32_bf16 v[68:71], v[128:131], v[148:151], v[68:71]
    ds_read_b64_tr_b16 v[162:163], v26 offset:18432
    s_waitcnt lgkmcnt(9)
    v_mfma_f32_16x16x32_bf16 v[72:75], v[128:131], v[152:155], v[72:75]
    ds_read_b128 v[176:179], v31 offset:0
    s_waitcnt lgkmcnt(9)
    v_mfma_f32_16x16x32_bf16 v[76:79], v[128:131], v[156:159], v[76:79]
    ds_read_b128 v[180:183], v31 offset:2048
    s_waitcnt lgkmcnt(8)
    v_mfma_f32_16x16x32_bf16 v[80:83], v[132:135], v[144:147], v[80:83]
    ds_read_b128 v[184:187], v31 offset:4096
    v_mfma_f32_16x16x32_bf16 v[84:87], v[132:135], v[148:151], v[84:87]
    ds_read_b128 v[188:191], v31 offset:6144
    v_mfma_f32_16x16x32_bf16 v[88:91], v[132:135], v[152:155], v[88:91]
    ds_read_b64_tr_b16 v[164:165], v27 offset:16384
    v_mfma_f32_16x16x32_bf16 v[92:95], v[132:135], v[156:159], v[92:95]
    ds_read_b64_tr_b16 v[166:167], v27 offset:18432
    s_waitcnt lgkmcnt(10)
    v_mfma_f32_16x16x32_bf16 v[96:99], v[136:139], v[144:147], v[96:99]
    ds_read_b64_tr_b16 v[168:169], v28 offset:16384
    s_add_u32 s34, s34, 40960
    v_mfma_f32_16x16x32_bf16 v[100:103], v[136:139], v[148:151], v[100:103]
    ds_read_b64_tr_b16 v[170:171], v28 offset:18432
    s_cmp_ge_u32 s34, 163840
    v_mfma_f32_16x16x32_bf16 v[104:107], v[136:139], v[152:155], v[104:107]
    ds_read_b64_tr_b16 v[172:173], v29 offset:16384
    s_cselect_b32 s34, 0, s34
    v_mfma_f32_16x16x32_bf16 v[108:111], v[136:139], v[156:159], v[108:111]
    ds_read_b64_tr_b16 v[174:175], v29 offset:18432
    s_add_u32 s35, s35, 1
    s_waitcnt lgkmcnt(12)
    v_mfma_f32_16x16x32_bf16 v[112:115], v[140:143], v[144:147], v[112:115]
    v_mfma_f32_16x16x32_bf16 v[116:119], v[140:143], v[148:151], v[116:119]
    v_mfma_f32_16x16x32_bf16 v[120:123], v[140:143], v[152:155], v[120:123]
    v_mfma_f32_16x16x32_bf16 v[124:127], v[140:143], v[156:159], v[124:127]
    s_waitcnt lgkmcnt(9)
    v_mfma_f32_16x16x32_bf16 v[64:67], v[160:163], v[176:179], v[64:67]
    s_waitcnt lgkmcnt(8)
    v_mfma_f32_16x16x32_bf16 v[68:71], v[160:163], v[180:183], v[68:71]
    s_waitcnt lgkmcnt(7)
    v_mfma_f32_16x16x32_bf16 v[72:75], v[160:163], v[184:187], v[72:75]
    s_waitcnt lgkmcnt(0)
    v_mfma_f32_16x16x32_bf16 v[76:79], v[160:163], v[188:191], v[76:79]
    v_add_u32 v26, s34, v10
    v_add_u32 v27, s34, v11
    v_add_u32 v28, s34, v12
    v_add_u32 v29, s34, v13
    v_add_u32 v30, s34, v14
    v_add_u32 v31, s34, v15
    s_barrier
    ds_read_b64_tr_b16 v[128:129], v26 offset:0
    v_mfma_f32_16x16x32_bf16 v[80:83], v[164:167], v[176:179], v[80:83]
    ds_read_b64_tr_b16 v[130:131], v26 offset:2048
    v_mfma_f32_16x16x32_bf16 v[84:87], v[164:167], v[180:183], v[84:87]
    ds_read_b128 v[144:147], v30 offset:0
    v_mfma_f32_16x16x32_bf16 v[88:91], v[164:167], v[184:187], v[88:91]
    ds_read_b128 v[148:151], v30 offset:2048
    v_mfma_f32_16x16x32_bf16 v[92:95], v[164:167], v[188:191], v[92:95]
    ds_read_b128 v[152:155], v30 offset:4096
    v_mfma_f32_16x16x32_bf16 v[96:99], v[168:171], v[176:179], v[96:99]
    ds_read_b128 v[156:159], v30 offset:6144
    v_mfma_f32_16x16x32_bf16 v[100:103], v[168:171], v[180:183], v[100:103]
    ds_read_b64_tr_b16 v[132:133], v27 offset:0
    v_mfma_f32_16x16x32_bf16 v[104:107], v[168:171], v[184:187], v[104:107]
    ds_read_b64_tr_b16 v[134:135], v27 offset:2048
    v_mfma_f32_16x16x32_bf16 v[108:111], v[168:171], v[188:191], v[108:111]
    ds_read_b64_tr_b16 v[136:137], v28 offset:0
    v_mfma_f32_16x16x32_bf16 v[112:115], v[172:175], v[176:179], v[112:115]
    ds_read_b64_tr_b16 v[138:139], v28 offset:2048
    v_mfma_f32_16x16x32_bf16 v[116:119], v[172:175], v[180:183], v[116:119]
    ds_read_b64_tr_b16 v[140:141], v29 offset:0
    v_mfma_f32_16x16x32_bf16 v[120:123], v[172:175], v[184:187], v[120:123]
    ds_read_b64_tr_b16 v[142:143], v29 offset:2048
    v_mfma_f32_16x16x32_bf16 v[124:127], v[172:175], v[188:191], v[124:127]
    s_cmp_lt_u32 s35, 6
    s_cbranch_scc1 L_a1
    s_waitcnt lgkmcnt(9)
    v_mfma_f32_16x16x32_bf16 v[64:67], v[128:131], v[144:147], v[64:67]
    ds_read_b64_tr_b16 v[160:161], v26 offset:16384
    ds_read_b64_tr_b16 v[162:163], v26 offset:18432
    s_waitcnt lgkmcnt(10)
    v_mfma_f32_16x16x32_bf16 v[68:71], v[128:131], v[148:151], v[68:71]
    ds_read_b128 v[176:179], v31 offset:0
    ds_read_b128 v[180:183], v31 offset:2048
    s_waitcnt lgkmcnt(11)
    v_mfma_f32_16x16x32_bf16 v[72:75], v[128:131], v[152:155], v[72:75]
    ds_read_b128 v[184:187], v31 offset:4096
    ds_read_b128 v[188:191], v31 offset:6144
    s_waitcnt lgkmcnt(12)
    v_mfma_f32_16x16x32_bf16 v[76:79], v[128:131], v[156:159], v[76:79]
    ds_read_b64_tr_b16 v[164:165], v27 offset:16384
    ds_read_b64_tr_b16 v[166:167], v27 offset:18432
    s_waitcnt lgkmcnt(5)
    v_mfma_f32_16x16x32_bf16 v[64:67], v[160:163], v[176:179], v[64:67]
    ds_read_b64_tr_b16 v[168:169], v28 offset:16384
    ds_read_b64_tr_b16 v[170:171], v28 offset:18432
    s_waitcnt lgkmcnt(6)
    v_mfma_f32_16x16x32_bf16 v[68:71], v[160:163], v[180:183], v[68:71]
    ds_read_b64_tr_b16 v[172:173], v29 offset:16384
    ds_read_b64_tr_b16 v[174:175], v29 offset:18432
    s_waitcnt lgkmcnt(7)
    v_mfma_f32_16x16x32_bf16 v[72:75], v[160:163], v[184:187], v[72:75]
    s_waitcnt lgkmcnt(6)
    v_mfma_f32_16x16x32_bf16 v[76:79], v[160:163], v[188:191], v[76:79]
    v_mfma_f32_16x16x32_bf16 v[80:83], v[132:135], v[144:147], v[80:83]
    v_mfma_f32_16x16x32_bf16 v[84:87], v[132:135], v[148:151], v[84:87]
    v_mfma_f32_16x16x32_bf16 v[88:91], v[132:135], v[152:155], v[88:91]
    v_mfma_f32_16x16x32_bf16 v[92:95], v[132:135], v[156:159], v[92:95]
    s_waitcnt lgkmcnt(4)
    v_mfma_f32_16x16x32_bf16 v[80:83], v[164:167], v[176:179], v[80:83]
    v_cvt_pk_bf16_f32 v32, v64, v65
    v_cvt_pk_bf16_f32 v33, v66, v67
    v_mfma_f32_16x16x32_bf16 v[84:87], v[164:167], v[180:183], v[84:87]
    v_cvt_pk_bf16_f32 v34, v68, v69
    v_cvt_pk_bf16_f32 v35, v70, v71
    v_mfma_f32_16x16x32_bf16 v[88:91], v[164:167], v[184:187], v[88:91]
    ds_write_b64 v20, v[32:33] offset:0
    v_cvt_pk_bf16_f32 v36, v72, v73
    v_cvt_pk_bf16_f32 v37, v74, v75
    v_mfma_f32_16x16x32_bf16 v[92:95], v[164:167], v[188:191], v[92:95]
    ds_write_b64 v20, v[34:35] offset:8192
    v_cvt_pk_bf16_f32 v38, v76, v77
    v_cvt_pk_bf16_f32 v39, v78, v79
    v_mfma_f32_16x16x32_bf16 v[96:99], v[136:139], v[144:147], v[96:99]
    ds_write_b64 v20, v[36:37] offset:16384
    v_mfma_f32_16x16x32_bf16 v[100:103], v[136:139], v[148:151], v[100:103]
    ds_write_b64 v20, v[38:39] offset:24576
    v_mfma_f32_16x16x32_bf16 v[104:107], v[136:139], v[152:155], v[104:107]
    v_mfma_f32_16x16x32_bf16 v[108:111], v[136:139], v[156:159], v[108:111]
    s_waitcnt lgkmcnt(6)
    v_mfma_f32_16x16x32_bf16 v[96:99], v[168:171], v[176:179], v[96:99]
    v_cvt_pk_bf16_f32 v40, v80, v81
    v_cvt_pk_bf16_f32 v41, v82, v83
    v_mfma_f32_16x16x32_bf16 v[100:103], v[168:171], v[180:183], v[100:103]
    v_cvt_pk_bf16_f32 v42, v84, v85
    v_cvt_pk_bf16_f32 v43, v86, v87
    v_mfma_f32_16x16x32_bf16 v[104:107], v[168:171], v[184:187], v[104:107]
    ds_write_b64 v3, v[40:41] offset:0
    v_cvt_pk_bf16_f32 v44, v88, v89
    v_cvt_pk_bf16_f32 v45, v90, v91
    v_mfma_f32_16x16x32_bf16 v[108:111], v[168:171], v[188:191], v[108:111]
    ds_write_b64 v3, v[42:43] offset:8192
    v_cvt_pk_bf16_f32 v46, v92, v93
    v_cvt_pk_bf16_f32 v47, v94, v95
    v_mfma_f32_16x16x32_bf16 v[112:115], v[140:143], v[144:147], v[112:115]
    ds_write_b64 v3, v[44:45] offset:16384
    v_mfma_f32_16x16x32_bf16 v[116:119], v[140:143], v[148:151], v[116:119]
    ds_write_b64 v3, v[46:47] offset:24576
    v_mfma_f32_16x16x32_bf16 v[120:123], v[140:143], v[152:155], v[120:123]
    v_mfma_f32_16x16x32_bf16 v[124:127], v[140:143], v[156:159], v[124:127]
    s_waitcnt lgkmcnt(8)
    v_mfma_f32_16x16x32_bf16 v[112:115], v[172:175], v[176:179], v[112:115]
    v_cvt_pk_bf16_f32 v48, v96, v97
    v_cvt_pk_bf16_f32 v49, v98, v99
    v_mfma_f32_16x16x32_bf16 v[116:119], v[172:175], v[180:183], v[116:119]
    v_cvt_pk_bf16_f32 v50, v100, v101
    v_cvt_pk_bf16_f32 v51, v102, v103
    v_mfma_f32_16x16x32_bf16 v[120:123], v[172:175], v[184:187], v[120:123]
    ds_write_b64 v5, v[48:49] offset:0
    v_cvt_pk_bf16_f32 v52, v104, v105
    v_cvt_pk_bf16_f32 v53, v106, v107
    v_mfma_f32_16x16x32_bf16 v[124:127], v[172:175], v[188:191], v[124:127]
    ds_write_b64 v5, v[50:51] offset:8192
    v_cvt_pk_bf16_f32 v54, v108, v109
    v_cvt_pk_bf16_f32 v55, v110, v111
    ds_write_b64 v5, v[52:53] offset:16384
    ds_write_b64 v5, v[54:55] offset:24576
    s_nop 5
    v_cvt_pk_bf16_f32 v56, v112, v113
    v_cvt_pk_bf16_f32 v57, v114, v115
    ds_write_b64 v6, v[56:57] offset:0
    v_cvt_pk_bf16_f32 v58, v116, v117
    v_cvt_pk_bf16_f32 v59, v118, v119
    ds_write_b64 v6, v[58:59] offset:8192
    v_cvt_pk_bf16_f32 v60, v120, v121
    v_cvt_pk_bf16_f32 v61, v122, v123
    ds_write_b64 v6, v[60:61] offset:16384
    v_cvt_pk_bf16_f32 v62, v124, v125
    v_cvt_pk_bf16_f32 v63, v126, v127
    ds_write_b64 v6, v[62:63] offset:24576
    s_lshl_b32 s32, s14, 13
    s_add_u32 s32, s32, 40960
    v_add_u32 v26, s32, v16
    v_add_u32 v27, s32, v17
    v_add_u32 v28, s32, v18
    v_add_u32 v29, s32, v19
    s_waitcnt lgkmcnt(0)
    v_mov_b32 v62, 0
    global_load_dwordx2 v[62:63], v62, s[30:31]
    s_barrier
    ds_read_b128 v[160:163], v26 offset:0
    ds_read_b128 v[192:195], v7 offset:0
    ds_read_b128 v[196:199], v7 offset:8192
    ds_read_b128 v[200:203], v7 offset:16384
    ds_read_b128 v[204:207], v7 offset:24576
    ds_read_b128 v[164:167], v27 offset:0
    ds_read_b128 v[208:211], v8 offset:0
    ds_read_b128 v[212:215], v8 offset:8192
    ds_read_b128 v[216:219], v8 offset:16384
    ds_read_b128 v[220:223], v8 offset:24576
    s_waitcnt lgkmcnt(8)
    v_mfma_f32_16x16x32_bf16 v[32:35], v[192:195], v[160:163], 0
    ds_read_b128 v[168:171], v28 offset:0
    ds_read_b128 v[224:227], v9 offset:0
    s_waitcnt lgkmcnt(9)
    v_mfma_f32_16x16x32_bf16 v[36:39], v[196:199], v[160:163], 0
    ds_read_b128 v[228:231], v9 offset:8192
    ds_read_b128 v[232:235], v9 offset:16384
    s_waitcnt lgkmcnt(10)
    v_mfma_f32_16x16x32_bf16 v[40:43], v[200:203], v[160:163], 0
    ds_read_b128 v[236:239], v9 offset:24576
    ds_read_b128 v[172:175], v29 offset:0
    s_waitcnt lgkmcnt(11)
    v_mfma_f32_16x16x32_bf16 v[44:47], v[204:207], v[160:163], 0
    ds_read_b128 v[240:243], v25 offset:0
    ds_read_b128 v[244:247], v25 offset:8192
    s_waitcnt lgkmcnt(11)
    v_mfma_f32_16x16x32_bf16 v[32:35], v[208:211], v[164:167], v[32:35]
    ds_read_b128 v[248:251], v25 offset:16384
    ds_read_b128 v[252:255], v25 offset:24576
    s_waitcnt lgkmcnt(12)
    v_mfma_f32_16x16x32_bf16 v[36:39], v[212:215], v[164:167], v[36:39]
    ds_read_b128 v[176:179], v26 offset:256
    ds_read_b128 v[192:195], v7 offset:256
    s_waitcnt lgkmcnt(13)
    v_mfma_f32_16x16x32_bf16 v[40:43], v[216:219], v[164:167], v[40:43]
    ds_read_b128 v[196:199], v7 offset:8448
    s_waitcnt lgkmcnt(13)
    v_mfma_f32_16x16x32_bf16 v[44:47], v[220:223], v[164:167], v[44:47]
    ds_read_b128 v[200:203], v7 offset:16640
    s_waitcnt lgkmcnt(12)
    v_mfma_f32_16x16x32_bf16 v[32:35], v[224:227], v[168:171], v[32:35]
    ds_read_b128 v[204:207], v7 offset:24832
    ds_read_b128 v[180:183], v27 offset:256
    s_waitcnt lgkmcnt(13)
    v_mfma_f32_16x16x32_bf16 v[36:39], v[228:231], v[168:171], v[36:39]
    ds_read_b128 v[208:211], v8 offset:256
    s_waitcnt lgkmcnt(13)
    v_mfma_f32_16x16x32_bf16 v[40:43], v[232:235], v[168:171], v[40:43]
    ds_read_b128 v[212:215], v8 offset:8448
    s_waitcnt lgkmcnt(13)
    v_mfma_f32_16x16x32_bf16 v[44:47], v[236:239], v[168:171], v[44:47]
    ds_read_b128 v[216:219], v8 offset:16640
    s_waitcnt lgkmcnt(12)
    v_mfma_f32_16x16x32_bf16 v[32:35], v[240:243], v[172:175], v[32:35]
    ds_read_b128 v[220:223], v8 offset:24832
    ds_read_b128 v[184:187], v28 offset:256
    s_waitcnt lgkmcnt(13)
    v_mfma_f32_16x16x32_bf16 v[36:39], v[244:247], v[172:175], v[36:39]
    ds_read_b128 v[224:227], v9 offset:256
    s_waitcnt lgkmcnt(13)
    v_mfma_f32_16x16x32_bf16 v[40:43], v[248:251], v[172:175], v[40:43]
    ds_read_b128 v[228:231], v9 offset:8448
    s_waitcnt lgkmcnt(13)
    v_mfma_f32_16x16x32_bf16 v[44:47], v[252:255], v[172:175], v[44:47]
    ds_read_b128 v[232:235], v9 offset:16640
    s_waitcnt lgkmcnt(12)
    v_mfma_f32_16x16x32_bf16 v[32:35], v[192:195], v[176:179], v[32:35]
    ds_read_b128 v[236:239], v9 offset:24832
    ds_read_b128 v[188:191], v29 offset:256
    s_waitcnt lgkmcnt(13)
    v_mfma_f32_16x16x32_bf16 v[36:39], v[196:199], v[176:179], v[36:39]
    ds_read_b128 v[240:243], v25 offset:256
    s_waitcnt lgkmcnt(13)
    v_mfma_f32_16x16x32_bf16 v[40:43], v[200:203], v[176:179], v[40:43]
    ds_read_b128 v[244:247], v25 offset:8448
    s_waitcnt lgkmcnt(13)
    v_mfma_f32_16x16x32_bf16 v[44:47], v[204:207], v[176:179], v[44:47]
    ds_read_b128 v[248:251], v25 offset:16640
    s_waitcnt lgkmcnt(12)
    v_mfma_f32_16x16x32_bf16 v[32:35], v[208:211], v[180:183], v[32:35]
    ds_read_b128 v[252:255], v25 offset:24832
    s_waitcnt lgkmcnt(12)
    v_mfma_f32_16x16x32_bf16 v[36:39], v[212:215], v[180:183], v[36:39]
    s_waitcnt lgkmcnt(11)
    v_mfma_f32_16x16x32_bf16 v[40:43], v[216:219], v[180:183], v[40:43]
    s_waitcnt lgkmcnt(10)
    v_mfma_f32_16x16x32_bf16 v[44:47], v[220:223], v[180:183], v[44:47]
    s_waitcnt lgkmcnt(8)
    v_mfma_f32_16x16x32_bf16 v[32:35], v[224:227], v[184:187], v[32:35]
    s_waitcnt lgkmcnt(7)
    v_mfma_f32_16x16x32_bf16 v[36:39], v[228:231], v[184:187], v[36:39]
    s_waitcnt lgkmcnt(6)
    v_mfma_f32_16x16x32_bf16 v[40:43], v[232:235], v[184:187], v[40:43]
    s_waitcnt lgkmcnt(5)
    v_mfma_f32_16x16x32_bf16 v[44:47], v[236:239], v[184:187], v[44:47]
    s_waitcnt lgkmcnt(3)
    v_mfma_f32_16x16x32_bf16 v[32:35], v[240:243], v[188:191], v[32:35]
    s_waitcnt lgkmcnt(2)
    v_mfma_f32_16x16x32_bf16 v[36:39], v[244:247], v[188:191], v[36:39]
    s_waitcnt lgkmcnt(1)
    v_mfma_f32_16x16x32_bf16 v[40:43], v[248:251], v[188:191], v[40:43]
    s_waitcnt lgkmcnt(0)
    v_mfma_f32_16x16x32_bf16 v[44:47], v[252:255], v[188:191], v[44:47]
    v_add_u32 v26, 0, v21
    v_add_u32 v27, 0, v22
    v_add_u32 v30, 0, v14
    v_add_u32 v31, 0, v15
    s_barrier
    ds_read_b64_tr_b16 v[128:129], v26 offset:0
    ds_read_b64_tr_b16 v[130:131], v26 offset:1024
    ds_read_b128 v[144:147], v30 offset:0
    ds_read_b128 v[148:151], v30 offset:2048
    ds_read_b128 v[152:155], v30 offset:4096
    ds_read_b128 v[156:159], v30 offset:6144
    ds_read_b64_tr_b16 v[132:133], v27 offset:0
    ds_read_b64_tr_b16 v[134:135], v27 offset:1024
    ds_read_b64_tr_b16 v[136:137], v26 offset:16384
    ds_read_b64_tr_b16 v[138:139], v26 offset:17408
    ds_read_b64_tr_b16 v[140:141], v27 offset:16384
    ds_read_b64_tr_b16 v[142:143], v27 offset:17408
    s_waitcnt lgkmcnt(9)
    v_mfma_f32_16x16x32_bf16 v[64:67], v[144:147], v[128:131], 0
    ds_read_b64_tr_b16 v[160:161], v26 offset:8192
    v_max3_f32 v48, v32, v33, v34
    v_max3_f32 v49, v35, v36, v37
    v_max3_f32 v50, v38, v39, v40
    v_max3_f32 v51, v41, v42, v43
    s_waitcnt lgkmcnt(9)
    v_mfma_f32_16x16x32_bf16 v[68:71], v[148:151], v[128:131], 0
    ds_read_b64_tr_b16 v[162:163], v26 offset:9216
    v_max3_f32 v48, v48, v44, v45
    v_max3_f32 v49, v49, v46, v47
    v_max3_f32 v48, v48, v50, v51
    v_max_f32 v48, v48, v49
    s_waitcnt lgkmcnt(9)
    v_mfma_f32_16x16x32_bf16 v[72:75], v[152:155], v[128:131], 0
    ds_read_b128 v[176:179], v31 offset:0
    v_mov_b32 v49, v48
    s_nop 1
    v_permlane16_swap_b32 v48, v49
    v_max_f32 v48, v48, v49
    s_waitcnt lgkmcnt(9)
    v_mfma_f32_16x16x32_bf16 v[76:79], v[156:159], v[128:131], 0
    ds_read_b128 v[180:183], v31 offset:2048
    v_mov_b32 v49, v48
    s_nop 1
    v_permlane32_swap_b32 v48, v49
    v_max_f32 v48, v48, v49
    s_waitcnt lgkmcnt(8)
    v_mfma_f32_16x16x32_bf16 v[80:83], v[144:147], v[132:135], 0
    ds_read_b128 v[184:187], v31 offset:4096
    v_mul_f32 v48, s46, v48
    v_fma_f32 v32, v32, s46, -v48
    v_fma_f32 v33, v33, s46, -v48
    v_fma_f32 v34, v34, s46, -v48
    v_mfma_f32_16x16x32_bf16 v[84:87], v[148:151], v[132:135], 0
    ds_read_b128 v[188:191], v31 offset:6144
    v_fma_f32 v35, v35, s46, -v48
    v_fma_f32 v36, v36, s46, -v48
    v_fma_f32 v37, v37, s46, -v48
    v_fma_f32 v38, v38, s46, -v48
    v_mfma_f32_16x16x32_bf16 v[88:91], v[152:155], v[132:135], 0
    ds_read_b64_tr_b16 v[164:165], v27 offset:8192
    v_fma_f32 v39, v39, s46, -v48
    v_fma_f32 v40, v40, s46, -v48
    v_fma_f32 v41, v41, s46, -v48
    v_fma_f32 v42, v42, s46, -v48
    v_mfma_f32_16x16x32_bf16 v[92:95], v[156:159], v[132:135], 0
    ds_read_b64_tr_b16 v[166:167], v27 offset:9216
    v_fma_f32 v43, v43, s46, -v48
    v_fma_f32 v44, v44, s46, -v48
    v_fma_f32 v45, v45, s46, -v48
    v_fma_f32 v46, v46, s46, -v48
    s_waitcnt lgkmcnt(10)
    v_mfma_f32_16x16x32_bf16 v[96:99], v[144:147], v[136:139], 0
    ds_read_b64_tr_b16 v[168:169], v26 offset:24576
    v_fma_f32 v47, v47, s46, -v48
    v_exp_f32 v32, v32
    v_exp_f32 v33, v33
    v_exp_f32 v34, v34
    v_mfma_f32_16x16x32_bf16 v[100:103], v[148:151], v[136:139], 0
    ds_read_b64_tr_b16 v[170:171], v26 offset:25600
    v_exp_f32 v35, v35
    v_exp_f32 v36, v36
    v_exp_f32 v37, v37
    v_exp_f32 v38, v38
    v_mfma_f32_16x16x32_bf16 v[104:107], v[152:155], v[136:139], 0
    ds_read_b64_tr_b16 v[172:173], v27 offset:24576
    v_exp_f32 v39, v39
    v_exp_f32 v40, v40
    v_exp_f32 v41, v41
    v_exp_f32 v42, v42
    v_mfma_f32_16x16x32_bf16 v[108:111], v[156:159], v[136:139], 0
    ds_read_b64_tr_b16 v[174:175], v27 offset:25600
    v_exp_f32 v43, v43
    v_exp_f32 v44, v44
    v_exp_f32 v45, v45
    v_exp_f32 v46, v46
    s_waitcnt lgkmcnt(12)
    v_mfma_f32_16x16x32_bf16 v[112:115], v[144:147], v[140:143], 0
    v_exp_f32 v47, v47
    v_add_f32 v50, v32, v33
    v_add_f32 v51, v34, v35
    v_add_f32 v50, v50, v36
    v_mfma_f32_16x16x32_bf16 v[116:119], v[148:151], v[140:143], 0
    v_add_f32 v51, v51, v37
    v_add_f32 v50, v50, v38
    v_add_f32 v51, v51, v39
    v_add_f32 v50, v50, v40
    v_mfma_f32_16x16x32_bf16 v[120:123], v[152:155], v[140:143], 0
    v_add_f32 v51, v51, v41
    v_add_f32 v50, v50, v42
    v_add_f32 v51, v51, v43
    v_add_f32 v50, v50, v44
    v_mfma_f32_16x16x32_bf16 v[124:127], v[156:159], v[140:143], 0
    v_add_f32 v51, v51, v45
    v_add_f32 v50, v50, v46
    v_add_f32 v51, v51, v47
    v_add_f32 v50, v50, v51
    s_waitcnt lgkmcnt(9)
    v_mfma_f32_16x16x32_bf16 v[64:67], v[176:179], v[160:163], v[64:67]
    v_mov_b32 v49, v50
    s_nop 1
    v_permlane16_swap_b32 v50, v49
    v_add_f32 v50, v50, v49
    s_waitcnt lgkmcnt(8)
    v_mfma_f32_16x16x32_bf16 v[68:71], v[180:183], v[160:163], v[68:71]
    v_mov_b32 v49, v50
    s_nop 1
    v_permlane32_swap_b32 v50, v49
    v_add_f32 v50, v50, v49
    s_waitcnt lgkmcnt(7)
    v_mfma_f32_16x16x32_bf16 v[72:75], v[184:187], v[160:163], v[72:75]
    v_rcp_f32 v50, v50
    s_nop 0
    v_mul_f32 v32, v32, v50
    v_mul_f32 v33, v33, v50
    s_waitcnt lgkmcnt(0)
    v_mfma_f32_16x16x32_bf16 v[76:79], v[188:191], v[160:163], v[76:79]
    v_add_u32 v26, 81920, v21
    v_add_u32 v27, 81920, v22
    v_add_u32 v30, 81920, v14
    v_add_u32 v31, 81920, v15
    s_barrier
    ds_read_b64_tr_b16 v[128:129], v26 offset:0
    v_mul_f32 v34, v34, v50
    v_mul_f32 v35, v35, v50
    v_mul_f32 v36, v36, v50
    v_mul_f32 v37, v37, v50
    v_mfma_f32_16x16x32_bf16 v[80:83], v[176:179], v[164:167], v[80:83]
    ds_read_b64_tr_b16 v[130:131], v26 offset:1024
    v_mul_f32 v38, v38, v50
    v_mul_f32 v39, v39, v50
    v_mul_f32 v40, v40, v50
    v_mul_f32 v41, v41, v50
    v_mfma_f32_16x16x32_bf16 v[84:87], v[180:183], v[164:167], v[84:87]
    ds_read_b128 v[144:147], v30 offset:0
    v_mul_f32 v42, v42, v50
    v_mul_f32 v43, v43, v50
    v_mul_f32 v44, v44, v50
    v_mul_f32 v45, v45, v50
    v_mfma_f32_16x16x32_bf16 v[88:91], v[184:187], v[164:167], v[88:91]
    ds_read_b128 v[148:151], v30 offset:2048
    v_mul_f32 v46, v46, v50
    v_mul_f32 v47, v47, v50
    v_cvt_pk_bf16_f32 v52, v32, v33
    v_cvt_pk_bf16_f32 v53, v34, v35
    v_mfma_f32_16x16x32_bf16 v[92:95], v[188:191], v[164:167], v[92:95]
    ds_read_b128 v[152:155], v30 offset:4096
    v_cvt_pk_bf16_f32 v54, v36, v37
    v_cvt_pk_bf16_f32 v55, v38, v39
    v_cvt_pk_bf16_f32 v56, v40, v41
    v_cvt_pk_bf16_f32 v57, v42, v43
    v_mfma_f32_16x16x32_bf16 v[96:99], v[176:179], v[168:171], v[96:99]
    ds_read_b128 v[156:159], v30 offset:6144
    v_cvt_pk_bf16_f32 v58, v44, v45
    v_cvt_pk_bf16_f32 v59, v46, v47
    buffer_store_dwordx4 v[52:55], v23, s[52:55], s33 offen sc1
    buffer_store_dwordx4 v[56:59], v23, s[52:55], s33 offen offset:1024 sc1
    v_mfma_f32_16x16x32_bf16 v[100:103], v[180:183], v[168:171], v[100:103]
    ds_read_b64_tr_b16 v[132:133], v27 offset:0
    v_mfma_f32_16x16x32_bf16 v[104:107], v[184:187], v[168:171], v[104:107]
    ds_read_b64_tr_b16 v[134:135], v27 offset:1024
    v_mfma_f32_16x16x32_bf16 v[108:111], v[188:191], v[168:171], v[108:111]
    ds_read_b64_tr_b16 v[136:137], v26 offset:16384
    v_mfma_f32_16x16x32_bf16 v[112:115], v[176:179], v[172:175], v[112:115]
    ds_read_b64_tr_b16 v[138:139], v26 offset:17408
    v_mfma_f32_16x16x32_bf16 v[116:119], v[180:183], v[172:175], v[116:119]
    ds_read_b64_tr_b16 v[140:141], v27 offset:16384
    v_mfma_f32_16x16x32_bf16 v[120:123], v[184:187], v[172:175], v[120:123]
    ds_read_b64_tr_b16 v[142:143], v27 offset:17408
    v_mfma_f32_16x16x32_bf16 v[124:127], v[188:191], v[172:175], v[124:127]
    s_waitcnt lgkmcnt(9)
    v_mfma_f32_16x16x32_bf16 v[64:67], v[144:147], v[128:131], v[64:67]
    ds_read_b64_tr_b16 v[160:161], v26 offset:8192
    s_waitcnt lgkmcnt(9)
    v_mfma_f32_16x16x32_bf16 v[68:71], v[148:151], v[128:131], v[68:71]
    ds_read_b64_tr_b16 v[162:163], v26 offset:9216
    s_waitcnt lgkmcnt(9)
    v_mfma_f32_16x16x32_bf16 v[72:75], v[152:155], v[128:131], v[72:75]
    ds_read_b128 v[176:179], v31 offset:0
    s_waitcnt lgkmcnt(9)
    v_mfma_f32_16x16x32_bf16 v[76:79], v[156:159], v[128:131], v[76:79]
    ds_read_b128 v[180:183], v31 offset:2048
    s_waitcnt lgkmcnt(8)
    v_mfma_f32_16x16x32_bf16 v[80:83], v[144:147], v[132:135], v[80:83]
    ds_read_b128 v[184:187], v31 offset:4096
    v_mfma_f32_16x16x32_bf16 v[84:87], v[148:151], v[132:135], v[84:87]
    ds_read_b128 v[188:191], v31 offset:6144
    v_mfma_f32_16x16x32_bf16 v[88:91], v[152:155], v[132:135], v[88:91]
    ds_read_b64_tr_b16 v[164:165], v27 offset:8192
    v_mfma_f32_16x16x32_bf16 v[92:95], v[156:159], v[132:135], v[92:95]
    ds_read_b64_tr_b16 v[166:167], v27 offset:9216
    s_waitcnt lgkmcnt(10)
    v_mfma_f32_16x16x32_bf16 v[96:99], v[144:147], v[136:139], v[96:99]
    ds_read_b64_tr_b16 v[168:169], v26 offset:24576
    v_mfma_f32_16x16x32_bf16 v[100:103], v[148:151], v[136:139], v[100:103]
    ds_read_b64_tr_b16 v[170:171], v26 offset:25600
    v_mfma_f32_16x16x32_bf16 v[104:107], v[152:155], v[136:139], v[104:107]
    ds_read_b64_tr_b16 v[172:173], v27 offset:24576
    v_mfma_f32_16x16x32_bf16 v[108:111], v[156:159], v[136:139], v[108:111]
    ds_read_b64_tr_b16 v[174:175], v27 offset:25600
    s_waitcnt lgkmcnt(12)
    v_mfma_f32_16x16x32_bf16 v[112:115], v[144:147], v[140:143], v[112:115]
    v_mfma_f32_16x16x32_bf16 v[116:119], v[148:151], v[140:143], v[116:119]
    v_mfma_f32_16x16x32_bf16 v[120:123], v[152:155], v[140:143], v[120:123]
    v_mfma_f32_16x16x32_bf16 v[124:127], v[156:159], v[140:143], v[124:127]
    s_waitcnt lgkmcnt(9)
    v_mfma_f32_16x16x32_bf16 v[64:67], v[176:179], v[160:163], v[64:67]
    s_waitcnt lgkmcnt(8)
    v_mfma_f32_16x16x32_bf16 v[68:71], v[180:183], v[160:163], v[68:71]
    s_waitcnt lgkmcnt(7)
    v_mfma_f32_16x16x32_bf16 v[72:75], v[184:187], v[160:163], v[72:75]
    s_waitcnt lgkmcnt(0)
    v_mfma_f32_16x16x32_bf16 v[76:79], v[188:191], v[160:163], v[76:79]
    v_add_u32 v26, 122880, v21
    v_add_u32 v27, 122880, v22
    v_add_u32 v30, 122880, v14
    v_add_u32 v31, 122880, v15
    s_barrier
    ds_read_b64_tr_b16 v[128:129], v26 offset:0
    v_mfma_f32_16x16x32_bf16 v[80:83], v[176:179], v[164:167], v[80:83]
    ds_read_b64_tr_b16 v[130:131], v26 offset:1024
    v_mfma_f32_16x16x32_bf16 v[84:87], v[180:183], v[164:167], v[84:87]
    ds_read_b128 v[144:147], v30 offset:0
    v_mfma_f32_16x16x32_bf16 v[88:91], v[184:187], v[164:167], v[88:91]
    ds_read_b128 v[148:151], v30 offset:2048
    v_mfma_f32_16x16x32_bf16 v[92:95], v[188:191], v[164:167], v[92:95]
    ds_read_b128 v[152:155], v30 offset:4096
    v_mfma_f32_16x16x32_bf16 v[96:99], v[176:179], v[168:171], v[96:99]
    ds_read_b128 v[156:159], v30 offset:6144
    v_mfma_f32_16x16x32_bf16 v[100:103], v[180:183], v[168:171], v[100:103]
    ds_read_b64_tr_b16 v[132:133], v27 offset:0
    v_mfma_f32_16x16x32_bf16 v[104:107], v[184:187], v[168:171], v[104:107]
    ds_read_b64_tr_b16 v[134:135], v27 offset:1024
    v_mfma_f32_16x16x32_bf16 v[108:111], v[188:191], v[168:171], v[108:111]
    ds_read_b64_tr_b16 v[136:137], v26 offset:16384
    v_mfma_f32_16x16x32_bf16 v[112:115], v[176:179], v[172:175], v[112:115]
    ds_read_b64_tr_b16 v[138:139], v26 offset:17408
    v_mfma_f32_16x16x32_bf16 v[116:119], v[180:183], v[172:175], v[116:119]
    ds_read_b64_tr_b16 v[140:141], v27 offset:16384
    v_mfma_f32_16x16x32_bf16 v[120:123], v[184:187], v[172:175], v[120:123]
    s_waitcnt vmcnt(0)
    v_readfirstlane_b32 s72, v62
    v_readfirstlane_b32 s73, v63
    s_nop 0
    s_or_b32 s32, s72, s73
    s_cmp_lg_u32 s32, 0
    s_cbranch_scc1 L_pfok
L_pfr:
    s_sleep 4
    v_mov_b32 v60, 0
    global_load_dwordx2 v[62:63], v60, s[30:31] sc1
    s_waitcnt vmcnt(0)
    v_readfirstlane_b32 s72, v62
    v_readfirstlane_b32 s73, v63
    s_nop 0
    s_or_b32 s32, s72, s73
    s_cmp_eq_u32 s32, 0
    s_cbranch_scc1 L_pfr
L_pfok:
    v_mov_b32 v60, s49
    s_mov_b64 exec, 1
    buffer_store_dwordx2 v[62:63], v60, s[52:55], 0 offen sc1
    s_mov_b64 exec, -1
    s_nop 3
    ds_read_b64_tr_b16 v[142:143], v27 offset:17408
    v_mfma_f32_16x16x32_bf16 v[124:127], v[188:191], v[172:175], v[124:127]
    s_waitcnt lgkmcnt(9)
    v_mfma_f32_16x16x32_bf16 v[64:67], v[144:147], v[128:131], v[64:67]
    ds_read_b64_tr_b16 v[160:161], v26 offset:8192
    s_waitcnt lgkmcnt(9)
    v_mfma_f32_16x16x32_bf16 v[68:71], v[148:151], v[128:131], v[68:71]
    ds_read_b64_tr_b16 v[162:163], v26 offset:9216
    s_waitcnt lgkmcnt(9)
    v_mfma_f32_16x16x32_bf16 v[72:75], v[152:155], v[128:131], v[72:75]
    ds_read_b128 v[176:179], v31 offset:0
    s_waitcnt lgkmcnt(9)
    v_mfma_f32_16x16x32_bf16 v[76:79], v[156:159], v[128:131], v[76:79]
    ds_read_b128 v[180:183], v31 offset:2048
    s_waitcnt lgkmcnt(8)
    v_mfma_f32_16x16x32_bf16 v[80:83], v[144:147], v[132:135], v[80:83]
    ds_read_b128 v[184:187], v31 offset:4096
    v_mfma_f32_16x16x32_bf16 v[84:87], v[148:151], v[132:135], v[84:87]
    ds_read_b128 v[188:191], v31 offset:6144
    v_mfma_f32_16x16x32_bf16 v[88:91], v[152:155], v[132:135], v[88:91]
    ds_read_b64_tr_b16 v[164:165], v27 offset:8192
    v_mfma_f32_16x16x32_bf16 v[92:95], v[156:159], v[132:135], v[92:95]
    ds_read_b64_tr_b16 v[166:167], v27 offset:9216
    s_waitcnt lgkmcnt(10)
    v_mfma_f32_16x16x32_bf16 v[96:99], v[144:147], v[136:139], v[96:99]
    ds_read_b64_tr_b16 v[168:169], v26 offset:24576
    v_mfma_f32_16x16x32_bf16 v[100:103], v[148:151], v[136:139], v[100:103]
    ds_read_b64_tr_b16 v[170:171], v26 offset:25600
    v_mfma_f32_16x16x32_bf16 v[104:107], v[152:155], v[136:139], v[104:107]
    ds_read_b64_tr_b16 v[172:173], v27 offset:24576
    v_mfma_f32_16x16x32_bf16 v[108:111], v[156:159], v[136:139], v[108:111]
    ds_read_b64_tr_b16 v[174:175], v27 offset:25600
    s_waitcnt lgkmcnt(12)
    v_mfma_f32_16x16x32_bf16 v[112:115], v[144:147], v[140:143], v[112:115]
    v_mfma_f32_16x16x32_bf16 v[116:119], v[148:151], v[140:143], v[116:119]
    v_mfma_f32_16x16x32_bf16 v[120:123], v[152:155], v[140:143], v[120:123]
    v_mfma_f32_16x16x32_bf16 v[124:127], v[156:159], v[140:143], v[124:127]
    s_waitcnt lgkmcnt(9)
    v_mfma_f32_16x16x32_bf16 v[64:67], v[176:179], v[160:163], v[64:67]
    s_waitcnt lgkmcnt(8)
    v_mfma_f32_16x16x32_bf16 v[68:71], v[180:183], v[160:163], v[68:71]
    s_waitcnt lgkmcnt(7)
    v_mfma_f32_16x16x32_bf16 v[72:75], v[184:187], v[160:163], v[72:75]
    s_waitcnt lgkmcnt(0)
    v_mfma_f32_16x16x32_bf16 v[76:79], v[188:191], v[160:163], v[76:79]
    v_add_u32 v26, 40960, v21
    v_add_u32 v27, 40960, v22
    v_add_u32 v30, 40960, v14
    v_add_u32 v31, 40960, v15
    s_barrier
    ds_read_b64_tr_b16 v[128:129], v26 offset:0
    v_mfma_f32_16x16x32_bf16 v[80:83], v[176:179], v[164:167], v[80:83]
    ds_read_b64_tr_b16 v[130:131], v26 offset:1024
    v_mfma_f32_16x16x32_bf16 v[84:87], v[180:183], v[164:167], v[84:87]
    ds_read_b128 v[144:147], v30 offset:0
    v_mfma_f32_16x16x32_bf16 v[88:91], v[184:187], v[164:167], v[88:91]
    ds_read_b128 v[148:151], v30 offset:2048
    v_mfma_f32_16x16x32_bf16 v[92:95], v[188:191], v[164:167], v[92:95]
    ds_read_b128 v[152:155], v30 offset:4096
    v_mfma_f32_16x16x32_bf16 v[96:99], v[176:179], v[168:171], v[96:99]
    ds_read_b128 v[156:159], v30 offset:6144
    v_mfma_f32_16x16x32_bf16 v[100:103], v[180:183], v[168:171], v[100:103]
    ds_read_b64_tr_b16 v[132:133], v27 offset:0
    v_mfma_f32_16x16x32_bf16 v[104:107], v[184:187], v[168:171], v[104:107]
    ds_read_b64_tr_b16 v[134:135], v27 offset:1024
    v_mfma_f32_16x16x32_bf16 v[108:111], v[188:191], v[168:171], v[108:111]
    ds_read_b64_tr_b16 v[136:137], v26 offset:16384
    v_mfma_f32_16x16x32_bf16 v[112:115], v[176:179], v[172:175], v[112:115]
    ds_read_b64_tr_b16 v[138:139], v26 offset:17408
    v_mfma_f32_16x16x32_bf16 v[116:119], v[180:183], v[172:175], v[116:119]
    ds_read_b64_tr_b16 v[140:141], v27 offset:16384
    v_mfma_f32_16x16x32_bf16 v[120:123], v[184:187], v[172:175], v[120:123]
    ds_read_b64_tr_b16 v[142:143], v27 offset:17408
    v_mfma_f32_16x16x32_bf16 v[124:127], v[188:191], v[172:175], v[124:127]
    s_waitcnt lgkmcnt(9)
    v_mfma_f32_16x16x32_bf16 v[64:67], v[144:147], v[128:131], v[64:67]
    ds_read_b64_tr_b16 v[160:161], v26 offset:8192
    s_waitcnt lgkmcnt(9)
    v_mfma_f32_16x16x32_bf16 v[68:71], v[148:151], v[128:131], v[68:71]
    ds_read_b64_tr_b16 v[162:163], v26 offset:9216
    s_waitcnt lgkmcnt(9)
    v_mfma_f32_16x16x32_bf16 v[72:75], v[152:155], v[128:131], v[72:75]
    ds_read_b128 v[176:179], v31 offset:0
    s_waitcnt lgkmcnt(9)
    v_mfma_f32_16x16x32_bf16 v[76:79], v[156:159], v[128:131], v[76:79]
    ds_read_b128 v[180:183], v31 offset:2048
    s_waitcnt lgkmcnt(8)
    v_mfma_f32_16x16x32_bf16 v[80:83], v[144:147], v[132:135], v[80:83]
    ds_read_b128 v[184:187], v31 offset:4096
    v_mfma_f32_16x16x32_bf16 v[84:87], v[148:151], v[132:135], v[84:87]
    ds_read_b128 v[188:191], v31 offset:6144
    v_mfma_f32_16x16x32_bf16 v[88:91], v[152:155], v[132:135], v[88:91]
    ds_read_b64_tr_b16 v[164:165], v27 offset:8192
    v_mfma_f32_16x16x32_bf16 v[92:95], v[156:159], v[132:135], v[92:95]
    ds_read_b64_tr_b16 v[166:167], v27 offset:9216
    s_waitcnt lgkmcnt(10)
    v_mfma_f32_16x16x32_bf16 v[96:99], v[144:147], v[136:139], v[96:99]
    ds_read_b64_tr_b16 v[168:169], v26 offset:24576
    v_mfma_f32_16x16x32_bf16 v[100:103], v[148:151], v[136:139], v[100:103]
    ds_read_b64_tr_b16 v[170:171], v26 offset:25600
    v_mfma_f32_16x16x32_bf16 v[104:107], v[152:155], v[136:139], v[104:107]
    ds_read_b64_tr_b16 v[172:173], v27 offset:24576
    v_mfma_f32_16x16x32_bf16 v[108:111], v[156:159], v[136:139], v[108:111]
    ds_read_b64_tr_b16 v[174:175], v27 offset:25600
    s_waitcnt lgkmcnt(12)
    v_mfma_f32_16x16x32_bf16 v[112:115], v[144:147], v[140:143], v[112:115]
    v_mfma_f32_16x16x32_bf16 v[116:119], v[148:151], v[140:143], v[116:119]
    v_mfma_f32_16x16x32_bf16 v[120:123], v[152:155], v[140:143], v[120:123]
    v_mfma_f32_16x16x32_bf16 v[124:127], v[156:159], v[140:143], v[124:127]
    s_waitcnt lgkmcnt(9)
    v_mfma_f32_16x16x32_bf16 v[64:67], v[176:179], v[160:163], v[64:67]
    s_waitcnt lgkmcnt(8)
    v_mfma_f32_16x16x32_bf16 v[68:71], v[180:183], v[160:163], v[68:71]
    s_waitcnt lgkmcnt(7)
    v_mfma_f32_16x16x32_bf16 v[72:75], v[184:187], v[160:163], v[72:75]
    s_waitcnt lgkmcnt(0)
    v_mfma_f32_16x16x32_bf16 v[76:79], v[188:191], v[160:163], v[76:79]
    v_add_u32 v26, 0, v21
    v_add_u32 v27, 0, v22
    v_add_u32 v30, 0, v14
    v_add_u32 v31, 0, v15
    s_barrier
    ds_read_b64_tr_b16 v[128:129], v26 offset:0
    v_mfma_f32_16x16x32_bf16 v[80:83], v[176:179], v[164:167], v[80:83]
    ds_read_b64_tr_b16 v[130:131], v26 offset:1024
    v_mfma_f32_16x16x32_bf16 v[84:87], v[180:183], v[164:167], v[84:87]
    ds_read_b128 v[144:147], v30 offset:0
    v_mfma_f32_16x16x32_bf16 v[88:91], v[184:187], v[164:167], v[88:91]
    ds_read_b128 v[148:151], v30 offset:2048
    v_mfma_f32_16x16x32_bf16 v[92:95], v[188:191], v[164:167], v[92:95]
    ds_read_b128 v[152:155], v30 offset:4096
    v_mfma_f32_16x16x32_bf16 v[96:99], v[176:179], v[168:171], v[96:99]
    ds_read_b128 v[156:159], v30 offset:6144
    v_mfma_f32_16x16x32_bf16 v[100:103], v[180:183], v[168:171], v[100:103]
    ds_read_b64_tr_b16 v[132:133], v27 offset:0
    v_mfma_f32_16x16x32_bf16 v[104:107], v[184:187], v[168:171], v[104:107]
    ds_read_b64_tr_b16 v[134:135], v27 offset:1024
    v_mfma_f32_16x16x32_bf16 v[108:111], v[188:191], v[168:171], v[108:111]
    ds_read_b64_tr_b16 v[136:137], v26 offset:16384
    v_mfma_f32_16x16x32_bf16 v[112:115], v[176:179], v[172:175], v[112:115]
    ds_read_b64_tr_b16 v[138:139], v26 offset:17408
    v_mfma_f32_16x16x32_bf16 v[116:119], v[180:183], v[172:175], v[116:119]
    ds_read_b64_tr_b16 v[140:141], v27 offset:16384
    v_mfma_f32_16x16x32_bf16 v[120:123], v[184:187], v[172:175], v[120:123]
    ds_read_b64_tr_b16 v[142:143], v27 offset:17408
    v_mfma_f32_16x16x32_bf16 v[124:127], v[188:191], v[172:175], v[124:127]
    s_waitcnt lgkmcnt(9)
    v_mfma_f32_16x16x32_bf16 v[192:195], v[144:147], v[128:131], 0
    ds_read_b64_tr_b16 v[160:161], v26 offset:8192
    s_waitcnt lgkmcnt(9)
    v_mfma_f32_16x16x32_bf16 v[196:199], v[148:151], v[128:131], 0
    ds_read_b64_tr_b16 v[162:163], v26 offset:9216
    s_waitcnt lgkmcnt(9)
    v_mfma_f32_16x16x32_bf16 v[200:203], v[152:155], v[128:131], 0
    ds_read_b128 v[176:179], v31 offset:0
    s_waitcnt lgkmcnt(9)
    v_mfma_f32_16x16x32_bf16 v[204:207], v[156:159], v[128:131], 0
    ds_read_b128 v[180:183], v31 offset:2048
    s_waitcnt lgkmcnt(8)
    v_mfma_f32_16x16x32_bf16 v[208:211], v[144:147], v[132:135], 0
    ds_read_b128 v[184:187], v31 offset:4096
    v_mfma_f32_16x16x32_bf16 v[212:215], v[148:151], v[132:135], 0
    ds_read_b128 v[188:191], v31 offset:6144
    v_cvt_pk_bf16_f32 v32, v64, v65
    v_mfma_f32_16x16x32_bf16 v[216:219], v[152:155], v[132:135], 0
    ds_read_b64_tr_b16 v[164:165], v27 offset:8192
    v_cvt_pk_bf16_f32 v33, v66, v67
    v_mfma_f32_16x16x32_bf16 v[220:223], v[156:159], v[132:135], 0
    ds_read_b64_tr_b16 v[166:167], v27 offset:9216
    v_cvt_pk_bf16_f32 v34, v68, v69
    s_waitcnt lgkmcnt(10)
    v_mfma_f32_16x16x32_bf16 v[224:227], v[144:147], v[136:139], 0
    ds_read_b64_tr_b16 v[168:169], v26 offset:24576
    v_cvt_pk_bf16_f32 v35, v70, v71
    v_mfma_f32_16x16x32_bf16 v[228:231], v[148:151], v[136:139], 0
    ds_read_b64_tr_b16 v[170:171], v26 offset:25600
    v_cvt_pk_bf16_f32 v36, v72, v73
    v_mfma_f32_16x16x32_bf16 v[232:235], v[152:155], v[136:139], 0
    ds_read_b64_tr_b16 v[172:173], v27 offset:24576
    v_cvt_pk_bf16_f32 v37, v74, v75
    v_mfma_f32_16x16x32_bf16 v[236:239], v[156:159], v[136:139], 0
    ds_read_b64_tr_b16 v[174:175], v27 offset:25600
    v_cvt_pk_bf16_f32 v38, v76, v77
    s_waitcnt lgkmcnt(12)
    v_mfma_f32_16x16x32_bf16 v[240:243], v[144:147], v[140:143], 0
    v_cvt_pk_bf16_f32 v39, v78, v79
    v_mfma_f32_16x16x32_bf16 v[244:247], v[148:151], v[140:143], 0
    v_mfma_f32_16x16x32_bf16 v[248:251], v[152:155], v[140:143], 0
    v_mfma_f32_16x16x32_bf16 v[252:255], v[156:159], v[140:143], 0
    s_waitcnt lgkmcnt(9)
    v_mfma_f32_16x16x32_bf16 v[192:195], v[176:179], v[160:163], v[192:195]
    v_cvt_pk_bf16_f32 v40, v80, v81
    s_waitcnt lgkmcnt(8)
    v_mfma_f32_16x16x32_bf16 v[196:199], v[180:183], v[160:163], v[196:199]
    v_cvt_pk_bf16_f32 v41, v82, v83
    s_waitcnt lgkmcnt(7)
    v_mfma_f32_16x16x32_bf16 v[200:203], v[184:187], v[160:163], v[200:203]
    v_cvt_pk_bf16_f32 v42, v84, v85
    s_waitcnt lgkmcnt(0)
    v_mfma_f32_16x16x32_bf16 v[204:207], v[188:191], v[160:163], v[204:207]
    v_add_u32 v26, 81920, v21
    v_add_u32 v27, 81920, v22
    v_add_u32 v30, 81920, v14
    v_add_u32 v31, 81920, v15
    s_barrier
    ds_read_b64_tr_b16 v[128:129], v26 offset:0
    v_cvt_pk_bf16_f32 v43, v86, v87
    v_mfma_f32_16x16x32_bf16 v[208:211], v[176:179], v[164:167], v[208:211]
    ds_read_b64_tr_b16 v[130:131], v26 offset:1024
    v_cvt_pk_bf16_f32 v44, v88, v89
    v_mfma_f32_16x16x32_bf16 v[212:215], v[180:183], v[164:167], v[212:215]
    ds_read_b128 v[144:147], v30 offset:0
    v_cvt_pk_bf16_f32 v45, v90, v91
    v_mfma_f32_16x16x32_bf16 v[216:219], v[184:187], v[164:167], v[216:219]
    ds_read_b128 v[148:151], v30 offset:2048
    v_cvt_pk_bf16_f32 v46, v92, v93
    v_mfma_f32_16x16x32_bf16 v[220:223], v[188:191], v[164:167], v[220:223]
    ds_read_b128 v[152:155], v30 offset:4096
    v_cvt_pk_bf16_f32 v47, v94, v95
    v_mfma_f32_16x16x32_bf16 v[224:227], v[176:179], v[168:171], v[224:227]
    ds_read_b128 v[156:159], v30 offset:6144
    v_mfma_f32_16x16x32_bf16 v[228:231], v[180:183], v[168:171], v[228:231]
    ds_read_b64_tr_b16 v[132:133], v27 offset:0
    v_mfma_f32_16x16x32_bf16 v[232:235], v[184:187], v[168:171], v[232:235]
    ds_read_b64_tr_b16 v[134:135], v27 offset:1024
    v_mfma_f32_16x16x32_bf16 v[236:239], v[188:191], v[168:171], v[236:239]
    ds_read_b64_tr_b16 v[136:137], v26 offset:16384
    v_mfma_f32_16x16x32_bf16 v[240:243], v[176:179], v[172:175], v[240:243]
    ds_read_b64_tr_b16 v[138:139], v26 offset:17408
    v_mfma_f32_16x16x32_bf16 v[244:247], v[180:183], v[172:175], v[244:247]
    ds_read_b64_tr_b16 v[140:141], v27 offset:16384
    v_mfma_f32_16x16x32_bf16 v[248:251], v[184:187], v[172:175], v[248:251]
    ds_read_b64_tr_b16 v[142:143], v27 offset:17408
    v_mfma_f32_16x16x32_bf16 v[252:255], v[188:191], v[172:175], v[252:255]
    s_waitcnt lgkmcnt(9)
    v_mfma_f32_16x16x32_bf16 v[192:195], v[144:147], v[128:131], v[192:195]
    ds_read_b64_tr_b16 v[160:161], v26 offset:8192
    v_cvt_pk_bf16_f32 v48, v96, v97
    s_waitcnt lgkmcnt(9)
    v_mfma_f32_16x16x32_bf16 v[196:199], v[148:151], v[128:131], v[196:199]
    ds_read_b64_tr_b16 v[162:163], v26 offset:9216
    v_cvt_pk_bf16_f32 v49, v98, v99
    s_waitcnt lgkmcnt(9)
    v_mfma_f32_16x16x32_bf16 v[200:203], v[152:155], v[128:131], v[200:203]
    ds_read_b128 v[176:179], v31 offset:0
    v_cvt_pk_bf16_f32 v50, v100, v101
    s_waitcnt lgkmcnt(9)
    v_mfma_f32_16x16x32_bf16 v[204:207], v[156:159], v[128:131], v[204:207]
    ds_read_b128 v[180:183], v31 offset:2048
    v_cvt_pk_bf16_f32 v51, v102, v103
    s_waitcnt lgkmcnt(8)
    v_mfma_f32_16x16x32_bf16 v[208:211], v[144:147], v[132:135], v[208:211]
    ds_read_b128 v[184:187], v31 offset:4096
    v_cvt_pk_bf16_f32 v52, v104, v105
    v_mfma_f32_16x16x32_bf16 v[212:215], v[148:151], v[132:135], v[212:215]
    ds_read_b128 v[188:191], v31 offset:6144
    v_cvt_pk_bf16_f32 v53, v106, v107
    v_mfma_f32_16x16x32_bf16 v[216:219], v[152:155], v[132:135], v[216:219]
    ds_read_b64_tr_b16 v[164:165], v27 offset:8192
    v_cvt_pk_bf16_f32 v54, v108, v109
    v_mfma_f32_16x16x32_bf16 v[220:223], v[156:159], v[132:135], v[220:223]
    ds_read_b64_tr_b16 v[166:167], v27 offset:9216
    v_cvt_pk_bf16_f32 v55, v110, v111
    s_waitcnt lgkmcnt(10)
    v_mfma_f32_16x16x32_bf16 v[224:227], v[144:147], v[136:139], v[224:227]
    ds_read_b64_tr_b16 v[168:169], v26 offset:24576
    v_mfma_f32_16x16x32_bf16 v[228:231], v[148:151], v[136:139], v[228:231]
    ds_read_b64_tr_b16 v[170:171], v26 offset:25600
    v_mfma_f32_16x16x32_bf16 v[232:235], v[152:155], v[136:139], v[232:235]
    ds_read_b64_tr_b16 v[172:173], v27 offset:24576
    v_mfma_f32_16x16x32_bf16 v[236:239], v[156:159], v[136:139], v[236:239]
    ds_read_b64_tr_b16 v[174:175], v27 offset:25600
    s_waitcnt lgkmcnt(12)
    v_mfma_f32_16x16x32_bf16 v[240:243], v[144:147], v[140:143], v[240:243]
    v_mfma_f32_16x16x32_bf16 v[244:247], v[148:151], v[140:143], v[244:247]
    v_mfma_f32_16x16x32_bf16 v[248:251], v[152:155], v[140:143], v[248:251]
    v_mfma_f32_16x16x32_bf16 v[252:255], v[156:159], v[140:143], v[252:255]
    s_waitcnt lgkmcnt(9)
    v_mfma_f32_16x16x32_bf16 v[192:195], v[176:179], v[160:163], v[192:195]
    v_cvt_pk_bf16_f32 v56, v112, v113
    s_waitcnt lgkmcnt(8)
    v_mfma_f32_16x16x32_bf16 v[196:199], v[180:183], v[160:163], v[196:199]
    v_cvt_pk_bf16_f32 v57, v114, v115
    s_waitcnt lgkmcnt(7)
    v_mfma_f32_16x16x32_bf16 v[200:203], v[184:187], v[160:163], v[200:203]
    v_cvt_pk_bf16_f32 v58, v116, v117
    s_waitcnt lgkmcnt(0)
    v_mfma_f32_16x16x32_bf16 v[204:207], v[188:191], v[160:163], v[204:207]
    v_add_u32 v26, 122880, v21
    v_add_u32 v27, 122880, v22
    v_add_u32 v30, 122880, v14
    v_add_u32 v31, 122880, v15
    s_barrier
    ds_read_b64_tr_b16 v[128:129], v26 offset:0
    v_cvt_pk_bf16_f32 v59, v118, v119
    v_mfma_f32_16x16x32_bf16 v[208:211], v[176:179], v[164:167], v[208:211]
    ds_read_b64_tr_b16 v[130:131], v26 offset:1024
    v_cvt_pk_bf16_f32 v60, v120, v121
    v_mfma_f32_16x16x32_bf16 v[212:215], v[180:183], v[164:167], v[212:215]
    ds_read_b128 v[144:147], v30 offset:0
    v_cvt_pk_bf16_f32 v61, v122, v123
    v_mfma_f32_16x16x32_bf16 v[216:219], v[184:187], v[164:167], v[216:219]
    ds_read_b128 v[148:151], v30 offset:2048
    v_cvt_pk_bf16_f32 v62, v124, v125
    v_mfma_f32_16x16x32_bf16 v[220:223], v[188:191], v[164:167], v[220:223]
    ds_read_b128 v[152:155], v30 offset:4096
    v_cvt_pk_bf16_f32 v63, v126, v127
    v_mfma_f32_16x16x32_bf16 v[224:227], v[176:179], v[168:171], v[224:227]
    ds_read_b128 v[156:159], v30 offset:6144
    v_mfma_f32_16x16x32_bf16 v[228:231], v[180:183], v[168:171], v[228:231]
    ds_read_b64_tr_b16 v[132:133], v27 offset:0
    v_mfma_f32_16x16x32_bf16 v[232:235], v[184:187], v[168:171], v[232:235]
    ds_read_b64_tr_b16 v[134:135], v27 offset:1024
    v_mfma_f32_16x16x32_bf16 v[236:239], v[188:191], v[168:171], v[236:239]
    ds_read_b64_tr_b16 v[136:137], v26 offset:16384
    v_mfma_f32_16x16x32_bf16 v[240:243], v[176:179], v[172:175], v[240:243]
    ds_read_b64_tr_b16 v[138:139], v26 offset:17408
    v_mfma_f32_16x16x32_bf16 v[244:247], v[180:183], v[172:175], v[244:247]
    ds_read_b64_tr_b16 v[140:141], v27 offset:16384
    v_mfma_f32_16x16x32_bf16 v[248:251], v[184:187], v[172:175], v[248:251]
    ds_read_b64_tr_b16 v[142:143], v27 offset:17408
    v_mfma_f32_16x16x32_bf16 v[252:255], v[188:191], v[172:175], v[252:255]
    s_waitcnt lgkmcnt(9)
    v_mfma_f32_16x16x32_bf16 v[192:195], v[144:147], v[128:131], v[192:195]
    ds_read_b64_tr_b16 v[160:161], v26 offset:8192
    s_waitcnt lgkmcnt(9)
    v_mfma_f32_16x16x32_bf16 v[196:199], v[148:151], v[128:131], v[196:199]
    ds_read_b64_tr_b16 v[162:163], v26 offset:9216
    s_waitcnt lgkmcnt(9)
    v_mfma_f32_16x16x32_bf16 v[200:203], v[152:155], v[128:131], v[200:203]
    ds_read_b128 v[176:179], v31 offset:0
    s_waitcnt lgkmcnt(9)
    v_mfma_f32_16x16x32_bf16 v[204:207], v[156:159], v[128:131], v[204:207]
    ds_read_b128 v[180:183], v31 offset:2048
    s_waitcnt lgkmcnt(8)
    v_mfma_f32_16x16x32_bf16 v[208:211], v[144:147], v[132:135], v[208:211]
    ds_read_b128 v[184:187], v31 offset:4096
    v_mfma_f32_16x16x32_bf16 v[212:215], v[148:151], v[132:135], v[212:215]
    ds_read_b128 v[188:191], v31 offset:6144
    v_mfma_f32_16x16x32_bf16 v[216:219], v[152:155], v[132:135], v[216:219]
    ds_read_b64_tr_b16 v[164:165], v27 offset:8192
    v_mfma_f32_16x16x32_bf16 v[220:223], v[156:159], v[132:135], v[220:223]
    ds_read_b64_tr_b16 v[166:167], v27 offset:9216
    s_waitcnt lgkmcnt(10)
    v_mfma_f32_16x16x32_bf16 v[224:227], v[144:147], v[136:139], v[224:227]
    ds_read_b64_tr_b16 v[168:169], v26 offset:24576
    v_mfma_f32_16x16x32_bf16 v[228:231], v[148:151], v[136:139], v[228:231]
    ds_read_b64_tr_b16 v[170:171], v26 offset:25600
    v_mfma_f32_16x16x32_bf16 v[232:235], v[152:155], v[136:139], v[232:235]
    ds_read_b64_tr_b16 v[172:173], v27 offset:24576
    v_mfma_f32_16x16x32_bf16 v[236:239], v[156:159], v[136:139], v[236:239]
    ds_read_b64_tr_b16 v[174:175], v27 offset:25600
    s_waitcnt lgkmcnt(12)
    v_mfma_f32_16x16x32_bf16 v[240:243], v[144:147], v[140:143], v[240:243]
    v_mfma_f32_16x16x32_bf16 v[244:247], v[148:151], v[140:143], v[244:247]
    v_mfma_f32_16x16x32_bf16 v[248:251], v[152:155], v[140:143], v[248:251]
    v_mfma_f32_16x16x32_bf16 v[252:255], v[156:159], v[140:143], v[252:255]
    s_waitcnt lgkmcnt(9)
    v_mfma_f32_16x16x32_bf16 v[192:195], v[176:179], v[160:163], v[192:195]
    s_waitcnt lgkmcnt(8)
    v_mfma_f32_16x16x32_bf16 v[196:199], v[180:183], v[160:163], v[196:199]
    s_waitcnt lgkmcnt(7)
    v_mfma_f32_16x16x32_bf16 v[200:203], v[184:187], v[160:163], v[200:203]
    s_waitcnt lgkmcnt(0)
    v_mfma_f32_16x16x32_bf16 v[204:207], v[188:191], v[160:163], v[204:207]
    v_add_u32 v26, 40960, v21
    v_add_u32 v27, 40960, v22
    v_add_u32 v30, 40960, v14
    v_add_u32 v31, 40960, v15
    s_barrier
    ds_read_b64_tr_b16 v[128:129], v26 offset:0
    v_mfma_f32_16x16x32_bf16 v[208:211], v[176:179], v[164:167], v[208:211]
    ds_read_b64_tr_b16 v[130:131], v26 offset:1024
    v_mfma_f32_16x16x32_bf16 v[212:215], v[180:183], v[164:167], v[212:215]
    ds_read_b128 v[144:147], v30 offset:0
    v_mfma_f32_16x16x32_bf16 v[216:219], v[184:187], v[164:167], v[216:219]
    ds_read_b128 v[148:151], v30 offset:2048
    v_mfma_f32_16x16x32_bf16 v[220:223], v[188:191], v[164:167], v[220:223]
    ds_read_b128 v[152:155], v30 offset:4096
    v_mfma_f32_16x16x32_bf16 v[224:227], v[176:179], v[168:171], v[224:227]
    ds_read_b128 v[156:159], v30 offset:6144
    v_mfma_f32_16x16x32_bf16 v[228:231], v[180:183], v[168:171], v[228:231]
    ds_read_b64_tr_b16 v[132:133], v27 offset:0
    v_mfma_f32_16x16x32_bf16 v[232:235], v[184:187], v[168:171], v[232:235]
    ds_read_b64_tr_b16 v[134:135], v27 offset:1024
    v_mfma_f32_16x16x32_bf16 v[236:239], v[188:191], v[168:171], v[236:239]
    ds_read_b64_tr_b16 v[136:137], v26 offset:16384
    v_mfma_f32_16x16x32_bf16 v[240:243], v[176:179], v[172:175], v[240:243]
    ds_read_b64_tr_b16 v[138:139], v26 offset:17408
    v_mfma_f32_16x16x32_bf16 v[244:247], v[180:183], v[172:175], v[244:247]
    ds_read_b64_tr_b16 v[140:141], v27 offset:16384
    v_mfma_f32_16x16x32_bf16 v[248:251], v[184:187], v[172:175], v[248:251]
    ds_read_b64_tr_b16 v[142:143], v27 offset:17408
    v_mfma_f32_16x16x32_bf16 v[252:255], v[188:191], v[172:175], v[252:255]
    s_waitcnt lgkmcnt(9)
    v_mfma_f32_16x16x32_bf16 v[192:195], v[144:147], v[128:131], v[192:195]
    ds_read_b64_tr_b16 v[160:161], v26 offset:8192
    s_waitcnt lgkmcnt(9)
    v_mfma_f32_16x16x32_bf16 v[196:199], v[148:151], v[128:131], v[196:199]
    ds_read_b64_tr_b16 v[162:163], v26 offset:9216
    s_waitcnt lgkmcnt(9)
    v_mfma_f32_16x16x32_bf16 v[200:203], v[152:155], v[128:131], v[200:203]
    ds_read_b128 v[176:179], v31 offset:0
    s_waitcnt lgkmcnt(9)
    v_mfma_f32_16x16x32_bf16 v[204:207], v[156:159], v[128:131], v[204:207]
    ds_read_b128 v[180:183], v31 offset:2048
    s_waitcnt lgkmcnt(8)
    v_mfma_f32_16x16x32_bf16 v[208:211], v[144:147], v[132:135], v[208:211]
    ds_read_b128 v[184:187], v31 offset:4096
    v_mfma_f32_16x16x32_bf16 v[212:215], v[148:151], v[132:135], v[212:215]
    ds_read_b128 v[188:191], v31 offset:6144
    v_mfma_f32_16x16x32_bf16 v[216:219], v[152:155], v[132:135], v[216:219]
    ds_read_b64_tr_b16 v[164:165], v27 offset:8192
    v_mfma_f32_16x16x32_bf16 v[220:223], v[156:159], v[132:135], v[220:223]
    ds_read_b64_tr_b16 v[166:167], v27 offset:9216
    s_waitcnt lgkmcnt(10)
    v_mfma_f32_16x16x32_bf16 v[224:227], v[144:147], v[136:139], v[224:227]
    ds_read_b64_tr_b16 v[168:169], v26 offset:24576
    v_mfma_f32_16x16x32_bf16 v[228:231], v[148:151], v[136:139], v[228:231]
    ds_read_b64_tr_b16 v[170:171], v26 offset:25600
    v_mfma_f32_16x16x32_bf16 v[232:235], v[152:155], v[136:139], v[232:235]
    ds_read_b64_tr_b16 v[172:173], v27 offset:24576
    v_mfma_f32_16x16x32_bf16 v[236:239], v[156:159], v[136:139], v[236:239]
    ds_read_b64_tr_b16 v[174:175], v27 offset:25600
    s_waitcnt lgkmcnt(12)
    v_mfma_f32_16x16x32_bf16 v[240:243], v[144:147], v[140:143], v[240:243]
    v_mfma_f32_16x16x32_bf16 v[244:247], v[148:151], v[140:143], v[244:247]
    v_mfma_f32_16x16x32_bf16 v[248:251], v[152:155], v[140:143], v[248:251]
    v_mfma_f32_16x16x32_bf16 v[252:255], v[156:159], v[140:143], v[252:255]
    s_waitcnt lgkmcnt(9)
    v_mfma_f32_16x16x32_bf16 v[192:195], v[176:179], v[160:163], v[192:195]
    s_waitcnt lgkmcnt(8)
    v_mfma_f32_16x16x32_bf16 v[196:199], v[180:183], v[160:163], v[196:199]
    s_waitcnt lgkmcnt(7)
    v_mfma_f32_16x16x32_bf16 v[200:203], v[184:187], v[160:163], v[200:203]
    s_waitcnt lgkmcnt(0)
    v_mfma_f32_16x16x32_bf16 v[204:207], v[188:191], v[160:163], v[204:207]
    v_mfma_f32_16x16x32_bf16 v[208:211], v[176:179], v[164:167], v[208:211]
    v_mfma_f32_16x16x32_bf16 v[212:215], v[180:183], v[164:167], v[212:215]
    v_mfma_f32_16x16x32_bf16 v[216:219], v[184:187], v[164:167], v[216:219]
    v_mfma_f32_16x16x32_bf16 v[220:223], v[188:191], v[164:167], v[220:223]
    v_mfma_f32_16x16x32_bf16 v[224:227], v[176:179], v[168:171], v[224:227]
    v_mfma_f32_16x16x32_bf16 v[228:231], v[180:183], v[168:171], v[228:231]
    v_mfma_f32_16x16x32_bf16 v[232:235], v[184:187], v[168:171], v[232:235]
    v_mfma_f32_16x16x32_bf16 v[236:239], v[188:191], v[168:171], v[236:239]
    v_mfma_f32_16x16x32_bf16 v[240:243], v[176:179], v[172:175], v[240:243]
    v_mfma_f32_16x16x32_bf16 v[244:247], v[180:183], v[172:175], v[244:247]
    v_mfma_f32_16x16x32_bf16 v[248:251], v[184:187], v[172:175], v[248:251]
    v_mfma_f32_16x16x32_bf16 v[252:255], v[188:191], v[172:175], v[252:255]
    s_lshl_b32 s32, s60, 11
    s_add_u32 s39, s32, s47
    s_add_u32 s32, s32, s48
    v_add_u32 v26, s39, v23
    v_add_u32 v27, s32, v23
    s_barrier
    ds_read_b128 v[128:131], v26 offset:0
    ds_read_b128 v[132:135], v26 offset:1024
    ds_read_b128 v[136:139], v26 offset:8192
    ds_read_b128 v[140:143], v26 offset:9216
    ds_read_b128 v[144:147], v27 offset:0
    ds_read_b128 v[148:151], v27 offset:1024
    ds_read_b128 v[152:155], v27 offset:8192
    ds_read_b128 v[156:159], v27 offset:9216
    s_waitcnt lgkmcnt(7)
    v_mfma_f32_16x16x32_bf16 v[64:67], v[32:35], v[128:131], 0
    v_cvt_pk_bf16_f32 v96, v192, v193
    v_cvt_pk_bf16_f32 v97, v194, v195
    v_cvt_pk_bf16_f32 v98, v196, v197
    v_cvt_pk_bf16_f32 v99, v198, v199
    v_cvt_pk_bf16_f32 v100, v200, v201
    v_mfma_f32_16x16x32_bf16 v[68:71], v[40:43], v[128:131], 0
    v_cvt_pk_bf16_f32 v101, v202, v203
    v_cvt_pk_bf16_f32 v102, v204, v205
    v_cvt_pk_bf16_f32 v103, v206, v207
    v_cvt_pk_bf16_f32 v104, v208, v209
    v_cvt_pk_bf16_f32 v105, v210, v211
    s_waitcnt lgkmcnt(6)
    v_mfma_f32_16x16x32_bf16 v[64:67], v[36:39], v[132:135], v[64:67]
    v_cvt_pk_bf16_f32 v106, v212, v213
    v_cvt_pk_bf16_f32 v107, v214, v215
    v_cvt_pk_bf16_f32 v108, v216, v217
    v_cvt_pk_bf16_f32 v109, v218, v219
    v_cvt_pk_bf16_f32 v110, v220, v221
    v_mfma_f32_16x16x32_bf16 v[68:71], v[44:47], v[132:135], v[68:71]
    v_cvt_pk_bf16_f32 v111, v222, v223
    v_cvt_pk_bf16_f32 v112, v224, v225
    v_cvt_pk_bf16_f32 v113, v226, v227
    v_cvt_pk_bf16_f32 v114, v228, v229
    v_cvt_pk_bf16_f32 v115, v230, v231
    s_waitcnt lgkmcnt(5)
    v_mfma_f32_16x16x32_bf16 v[64:67], v[48:51], v[136:139], v[64:67]
    v_cvt_pk_bf16_f32 v116, v232, v233
    v_cvt_pk_bf16_f32 v117, v234, v235
    v_cvt_pk_bf16_f32 v118, v236, v237
    v_cvt_pk_bf16_f32 v119, v238, v239
    v_cvt_pk_bf16_f32 v120, v240, v241
    v_mfma_f32_16x16x32_bf16 v[68:71], v[56:59], v[136:139], v[68:71]
    v_cvt_pk_bf16_f32 v121, v242, v243
    v_cvt_pk_bf16_f32 v122, v244, v245
    v_cvt_pk_bf16_f32 v123, v246, v247
    v_cvt_pk_bf16_f32 v124, v248, v249
    v_cvt_pk_bf16_f32 v125, v250, v251
    s_waitcnt lgkmcnt(4)
    v_mfma_f32_16x16x32_bf16 v[64:67], v[52:55], v[140:143], v[64:67]
    v_cvt_pk_bf16_f32 v126, v252, v253
    v_cvt_pk_bf16_f32 v127, v254, v255
    s_lshl_b32 s32, s61, 11
    s_add_u32 s39, s32, s47
    s_add_u32 s32, s32, s48
    v_mfma_f32_16x16x32_bf16 v[68:71], v[60:63], v[140:143], v[68:71]
    v_add_u32 v28, s39, v23
    v_add_u32 v29, s32, v23
    s_waitcnt lgkmcnt(3)
    v_mfma_f32_16x16x32_bf16 v[64:67], v[96:99], v[144:147], v[64:67]
    ds_read_b128 v[160:163], v28 offset:0
    ds_read_b128 v[164:167], v28 offset:1024
    v_mfma_f32_16x16x32_bf16 v[68:71], v[104:107], v[144:147], v[68:71]
    ds_read_b128 v[168:171], v28 offset:8192
    ds_read_b128 v[172:175], v28 offset:9216
    s_waitcnt lgkmcnt(6)
    v_mfma_f32_16x16x32_bf16 v[64:67], v[100:103], v[148:151], v[64:67]
    ds_read_b128 v[176:179], v29 offset:0
    ds_read_b128 v[180:183], v29 offset:1024
    v_mfma_f32_16x16x32_bf16 v[68:71], v[108:111], v[148:151], v[68:71]
    ds_read_b128 v[184:187], v29 offset:8192
    ds_read_b128 v[188:191], v29 offset:9216
    s_waitcnt lgkmcnt(9)
    v_mfma_f32_16x16x32_bf16 v[64:67], v[112:115], v[152:155], v[64:67]
    v_mfma_f32_16x16x32_bf16 v[68:71], v[120:123], v[152:155], v[68:71]
    s_waitcnt lgkmcnt(8)
    v_mfma_f32_16x16x32_bf16 v[64:67], v[116:119], v[156:159], v[64:67]
    v_mfma_f32_16x16x32_bf16 v[68:71], v[124:127], v[156:159], v[68:71]
    s_waitcnt lgkmcnt(7)
    v_mfma_f32_16x16x32_bf16 v[72:75], v[32:35], v[160:163], 0
    s_lshl_b32 s32, s62, 11
    s_add_u32 s39, s32, s47
    v_mfma_f32_16x16x32_bf16 v[76:79], v[40:43], v[160:163], 0
    s_add_u32 s32, s32, s48
    v_add_u32 v26, s39, v23
    s_waitcnt lgkmcnt(6)
    v_mfma_f32_16x16x32_bf16 v[72:75], v[36:39], v[164:167], v[72:75]
    v_add_u32 v27, s32, v23
    v_mfma_f32_16x16x32_bf16 v[76:79], v[44:47], v[164:167], v[76:79]
    s_waitcnt lgkmcnt(5)
    v_mfma_f32_16x16x32_bf16 v[72:75], v[48:51], v[168:171], v[72:75]
    v_mfma_f32_16x16x32_bf16 v[76:79], v[56:59], v[168:171], v[76:79]
    v_cvt_pk_bf16_f32 v192, v64, v65
    v_cvt_pk_bf16_f32 v193, v66, v67
    s_waitcnt lgkmcnt(4)
    v_mfma_f32_16x16x32_bf16 v[72:75], v[52:55], v[172:175], v[72:75]
    v_cvt_pk_bf16_f32 v194, v68, v69
    v_cvt_pk_bf16_f32 v195, v70, v71
    v_mfma_f32_16x16x32_bf16 v[76:79], v[60:63], v[172:175], v[76:79]
    s_lshl_b32 s32, s60, 14
    s_add_u32 s43, s36, s32
    s_waitcnt lgkmcnt(3)
    v_mfma_f32_16x16x32_bf16 v[72:75], v[96:99], v[176:179], v[72:75]
    ds_read_b128 v[128:131], v26 offset:0
    ds_read_b128 v[132:135], v26 offset:1024
    v_permlane16_swap_b32 v192, v194
    v_permlane16_swap_b32 v193, v195
    v_mfma_f32_16x16x32_bf16 v[76:79], v[104:107], v[176:179], v[76:79]
    ds_read_b128 v[136:139], v26 offset:8192
    ds_read_b128 v[140:143], v26 offset:9216
    buffer_store_dwordx4 v[192:195], v23, s[52:55], s43 offen sc1
    s_waitcnt lgkmcnt(6)
    v_mfma_f32_16x16x32_bf16 v[72:75], v[100:103], v[180:183], v[72:75]
    ds_read_b128 v[144:147], v27 offset:0
    ds_read_b128 v[148:151], v27 offset:1024
    v_mfma_f32_16x16x32_bf16 v[76:79], v[108:111], v[180:183], v[76:79]
    ds_read_b128 v[152:155], v27 offset:8192
    ds_read_b128 v[156:159], v27 offset:9216
    s_waitcnt lgkmcnt(9)
    v_mfma_f32_16x16x32_bf16 v[72:75], v[112:115], v[184:187], v[72:75]
    v_mfma_f32_16x16x32_bf16 v[76:79], v[120:123], v[184:187], v[76:79]
    s_waitcnt lgkmcnt(8)
    v_mfma_f32_16x16x32_bf16 v[72:75], v[116:119], v[188:191], v[72:75]
    v_mfma_f32_16x16x32_bf16 v[76:79], v[124:127], v[188:191], v[76:79]
    s_waitcnt lgkmcnt(7)
    v_mfma_f32_16x16x32_bf16 v[80:83], v[32:35], v[128:131], 0
    s_lshl_b32 s32, s63, 11
    s_add_u32 s39, s32, s47
    v_mfma_f32_16x16x32_bf16 v[84:87], v[40:43], v[128:131], 0
    s_add_u32 s32, s32, s48
    v_add_u32 v28, s39, v23
    s_waitcnt lgkmcnt(6)
    v_mfma_f32_16x16x32_bf16 v[80:83], v[36:39], v[132:135], v[80:83]
    v_add_u32 v29, s32, v23
    v_mfma_f32_16x16x32_bf16 v[84:87], v[44:47], v[132:135], v[84:87]
    s_waitcnt lgkmcnt(5)
    v_mfma_f32_16x16x32_bf16 v[80:83], v[48:51], v[136:139], v[80:83]
    v_mfma_f32_16x16x32_bf16 v[84:87], v[56:59], v[136:139], v[84:87]
    v_cvt_pk_bf16_f32 v196, v72, v73
    v_cvt_pk_bf16_f32 v197, v74, v75
    s_waitcnt lgkmcnt(4)
    v_mfma_f32_16x16x32_bf16 v[80:83], v[52:55], v[140:143], v[80:83]
    v_cvt_pk_bf16_f32 v198, v76, v77
    v_cvt_pk_bf16_f32 v199, v78, v79
    v_mfma_f32_16x16x32_bf16 v[84:87], v[60:63], v[140:143], v[84:87]
    s_lshl_b32 s32, s61, 14
    s_add_u32 s43, s36, s32
    s_waitcnt lgkmcnt(3)
    v_mfma_f32_16x16x32_bf16 v[80:83], v[96:99], v[144:147], v[80:83]
    ds_read_b128 v[160:163], v28 offset:0
    ds_read_b128 v[164:167], v28 offset:1024
    v_permlane16_swap_b32 v196, v198
    v_permlane16_swap_b32 v197, v199
    v_mfma_f32_16x16x32_bf16 v[84:87], v[104:107], v[144:147], v[84:87]
    ds_read_b128 v[168:171], v28 offset:8192
    ds_read_b128 v[172:175], v28 offset:9216
    buffer_store_dwordx4 v[196:199], v23, s[52:55], s43 offen sc1
    s_waitcnt lgkmcnt(6)
    v_mfma_f32_16x16x32_bf16 v[80:83], v[100:103], v[148:151], v[80:83]
    ds_read_b128 v[176:179], v29 offset:0
    ds_read_b128 v[180:183], v29 offset:1024
    v_mfma_f32_16x16x32_bf16 v[84:87], v[108:111], v[148:151], v[84:87]
    ds_read_b128 v[184:187], v29 offset:8192
    ds_read_b128 v[188:191], v29 offset:9216
    s_waitcnt lgkmcnt(9)
    v_mfma_f32_16x16x32_bf16 v[80:83], v[112:115], v[152:155], v[80:83]
    v_mfma_f32_16x16x32_bf16 v[84:87], v[120:123], v[152:155], v[84:87]
    s_waitcnt lgkmcnt(8)
    v_mfma_f32_16x16x32_bf16 v[80:83], v[116:119], v[156:159], v[80:83]
    v_mfma_f32_16x16x32_bf16 v[84:87], v[124:127], v[156:159], v[84:87]
    s_waitcnt lgkmcnt(7)
    v_mfma_f32_16x16x32_bf16 v[88:91], v[32:35], v[160:163], 0
    v_mfma_f32_16x16x32_bf16 v[92:95], v[40:43], v[160:163], 0
    s_waitcnt lgkmcnt(6)
    v_mfma_f32_16x16x32_bf16 v[88:91], v[36:39], v[164:167], v[88:91]
    v_mfma_f32_16x16x32_bf16 v[92:95], v[44:47], v[164:167], v[92:95]
    s_waitcnt lgkmcnt(5)
    v_mfma_f32_16x16x32_bf16 v[88:91], v[48:51], v[168:171], v[88:91]
    v_mfma_f32_16x16x32_bf16 v[92:95], v[56:59], v[168:171], v[92:95]
    v_cvt_pk_bf16_f32 v200, v80, v81
    v_cvt_pk_bf16_f32 v201, v82, v83
    s_waitcnt lgkmcnt(4)
    v_mfma_f32_16x16x32_bf16 v[88:91], v[52:55], v[172:175], v[88:91]
    v_cvt_pk_bf16_f32 v202, v84, v85
    v_cvt_pk_bf16_f32 v203, v86, v87
    v_mfma_f32_16x16x32_bf16 v[92:95], v[60:63], v[172:175], v[92:95]
    s_lshl_b32 s32, s62, 14
    s_add_u32 s43, s36, s32
    s_waitcnt lgkmcnt(3)
    v_mfma_f32_16x16x32_bf16 v[88:91], v[96:99], v[176:179], v[88:91]
    v_permlane16_swap_b32 v200, v202
    v_permlane16_swap_b32 v201, v203
    v_mfma_f32_16x16x32_bf16 v[92:95], v[104:107], v[176:179], v[92:95]
    buffer_store_dwordx4 v[200:203], v23, s[52:55], s43 offen sc1
    s_waitcnt lgkmcnt(2)
    v_mfma_f32_16x16x32_bf16 v[88:91], v[100:103], v[180:183], v[88:91]
    v_mfma_f32_16x16x32_bf16 v[92:95], v[108:111], v[180:183], v[92:95]
    s_waitcnt lgkmcnt(1)
    v_mfma_f32_16x16x32_bf16 v[88:91], v[112:115], v[184:187], v[88:91]
    v_mfma_f32_16x16x32_bf16 v[92:95], v[120:123], v[184:187], v[92:95]
    s_waitcnt lgkmcnt(0)
    v_mfma_f32_16x16x32_bf16 v[88:91], v[116:119], v[188:191], v[88:91]
    v_mfma_f32_16x16x32_bf16 v[92:95], v[124:127], v[188:191], v[92:95]
    s_nop 2
    v_mov_b32 v4, s41
    v_lshlrev_b32 v5, 7, v2
    v_add_u32 v5, s40, v5
    s_cmp_ge_u32 s38, 14
    s_cbranch_scc1 L_fin
    v_permlane16_swap_b32 v88, v92
    v_permlane16_swap_b32 v89, v93
    v_permlane16_swap_b32 v90, v94
    v_permlane16_swap_b32 v91, v95
    s_or_b32 s32, s72, s73
    s_cmp_lg_u32 s32, 0
    s_cbranch_scc1 L_tnok
L_tn:
    s_sleep 4
    v_mov_b32 v6, 0
    global_load_dwordx2 v[10:11], v6, s[30:31] sc1
    s_waitcnt vmcnt(0)
    v_readfirstlane_b32 s72, v10
    v_readfirstlane_b32 s73, v11
    s_or_b32 s32, s72, s73
    s_cmp_eq_u32 s32, 0
    s_cbranch_scc1 L_tn
L_tnok:
    v_mov_b32 v10, s72
    v_mov_b32 v11, s73
    s_lshl_b32 s44, 1, s6
    s_xor_b32 s44, s44, 15
    s_mov_b32 s45, 0
    s_mov_b64 exec, s[44:45]
    buffer_load_dwordx2 v[8:9], v5, s[52:55], 0 offen sc1
    s_waitcnt vmcnt(0)
    s_mov_b64 exec, 1
    buffer_store_dwordx2 v[10:11], v4, s[52:55], 0 offen sc1
    s_mov_b64 exec, s[44:45]
    v_cmp_ne_u64 vcc, v[10:11], v[8:9]
    s_cbranch_vccz L_tpok
L_tpoll:
    buffer_load_dwordx2 v[8:9], v5, s[52:55], 0 offen sc1
    s_waitcnt vmcnt(0)
    v_cmp_ne_u64 vcc, v[10:11], v[8:9]
    s_cbranch_vccnz L_tpoll
L_tpok:
    s_mov_b64 exec, -1
    s_lshl_b32 s32, s60, 12
    s_add_u32 s43, s37, s32
    buffer_load_dwordx4 v[128:131], v23, s[52:55], s43 offen sc1
    s_lshl_b32 s32, s61, 12
    s_add_u32 s43, s37, s32
    buffer_load_dwordx4 v[132:135], v23, s[52:55], s43 offen sc1
    s_lshl_b32 s32, s62, 12
    s_add_u32 s43, s37, s32
    buffer_load_dwordx4 v[136:139], v23, s[52:55], s43 offen sc1
    s_waitcnt vmcnt(2)
    v_lshlrev_b32 v6, 16, v128
    v_and_b32 v7, 0xffff0000, v128
    v_add_f32 v88, v88, v6
    v_add_f32 v89, v89, v7
    v_lshlrev_b32 v6, 16, v129
    v_and_b32 v7, 0xffff0000, v129
    v_add_f32 v90, v90, v6
    v_add_f32 v91, v91, v7
    v_lshlrev_b32 v6, 16, v130
    v_and_b32 v7, 0xffff0000, v130
    v_add_f32 v92, v92, v6
    v_add_f32 v93, v93, v7
    v_lshlrev_b32 v6, 16, v131
    v_and_b32 v7, 0xffff0000, v131
    v_add_f32 v94, v94, v6
    v_add_f32 v95, v95, v7
    s_waitcnt vmcnt(1)
    v_lshlrev_b32 v6, 16, v132
    v_and_b32 v7, 0xffff0000, v132
    v_add_f32 v88, v88, v6
    v_add_f32 v89, v89, v7
    v_lshlrev_b32 v6, 16, v133
    v_and_b32 v7, 0xffff0000, v133
    v_add_f32 v90, v90, v6
    v_add_f32 v91, v91, v7
    v_lshlrev_b32 v6, 16, v134
    v_and_b32 v7, 0xffff0000, v134
    v_add_f32 v92, v92, v6
    v_add_f32 v93, v93, v7
    v_lshlrev_b32 v6, 16, v135
    v_and_b32 v7, 0xffff0000, v135
    v_add_f32 v94, v94, v6
    v_add_f32 v95, v95, v7
    s_waitcnt vmcnt(0)
    v_lshlrev_b32 v6, 16, v136
    v_and_b32 v7, 0xffff0000, v136
    v_add_f32 v88, v88, v6
    v_add_f32 v89, v89, v7
    v_lshlrev_b32 v6, 16, v137
    v_and_b32 v7, 0xffff0000, v137
    v_add_f32 v90, v90, v6
    v_add_f32 v91, v91, v7
    v_lshlrev_b32 v6, 16, v138
    v_and_b32 v7, 0xffff0000, v138
    v_add_f32 v92, v92, v6
    v_add_f32 v93, v93, v7
    v_lshlrev_b32 v6, 16, v139
    v_and_b32 v7, 0xffff0000, v139
    v_add_f32 v94, v94, v6
    v_add_f32 v95, v95, v7
    v_cvt_pk_bf16_f32 v28, v88, v89
    v_cvt_pk_bf16_f32 v29, v90, v91
    v_cvt_pk_bf16_f32 v30, v92, v93
    v_cvt_pk_bf16_f32 v31, v94, v95
    buffer_store_dwordx4 v[28:31], v24, s[56:59], s42 offen
L_fin:
    s_endpgm
L_loader:
    s_sub_u32 s14, s14, 4
    v_lshrrev_b32 v3, 5, v2
    v_and_b32 v4, 31, v2
    v_lshrrev_b32 v4, 1, v4
    v_and_b32 v5, 1, v2
    v_lshlrev_b32 v5, 4, v5
    v_lshrrev_b32 v6, 4, v2
    s_and_b32 s32, s14, 1
    s_lshl_b32 s33, s32, 2
    v_add_u32 v6, s33, v6
    v_and_b32 v7, 7, v2
    v_xor_b32 v6, v6, v7
    v_lshlrev_b32 v6, 4, v6
    v_lshrrev_b32 v7, 3, v2
    v_mul_u32_u24 v9, 896, v7
    v_add_u32 v11, v6, v9
    v_lshlrev_b32 v9, 9, v7
    v_add_u32 v14, v6, v9
    s_lshl_b32 s33, s32, 1
    v_add_u32 v6, s33, v3
    v_xor_b32 v6, v6, v4
    v_lshlrev_b32 v6, 5, v6
    v_lshlrev_b32 v7, 13, v3
    v_add_u32 v6, v6, v7
    v_add_u32 v10, v6, v5
    v_xor_b32 v8, 128, v10
    s_mul_i32 s56, s7, 57344
    s_mul_i32 s32, s14, 7168
    s_add_u32 s56, s56, s32
    s_lshl_b32 s57, s14, 10
    s_lshl_b32 s58, s9, 9
    s_lshl_b32 s33, s14, 14
    s_add_u32 s58, s58, s33
    s_cmp_eq_u32 s7, 7
    s_cselect_b32 s90, 0, s7
    s_mov_b32 s96, s7
    s_sub_u32 s97, s96, 5
    s_cmp_ge_u32 s96, 5
    s_cselect_b32 s96, s97, s96
    s_sub_u32 s97, s96, 5
    s_cmp_ge_u32 s96, 5
    s_cselect_b32 s96, s97, s96
    s_add_u32 s96, s96, 2
    s_mov_b32 s90, 0
    s_lshr_b32 s94, s7, 2
    s_and_b32 s95, s7, 3
    v_lshlrev_b32 v27, 7, v2
    s_waitcnt lgkmcnt(0)
    s_mov_b32 s40, s22
    s_and_b32 s41, s23, 0xffff
    s_mov_b32 s42, 3670016
    s_mov_b32 s43, 0x20000
    s_mov_b32 s36, s16
    s_and_b32 s37, s17, 0xffff
    s_mov_b32 s38, 458752
    s_mov_b32 s39, 0x20000
    s_lshl_b32 s92, s90, 19
    s_add_u32 s92, s92, s58
    s_lshl_b32 s93, s90, 7
    s_add_u32 s93, s93, s56
    s_add_u32 s90, s90, 1
    s_add_u32 m0, s57, 0
    s_add_u32 s32, s92, 0
    buffer_load_dwordx4 v10, s[40:43], s32 offen lds
    s_add_u32 m0, s57, 4096
    s_add_u32 s32, s92, 65536
    buffer_load_dwordx4 v8, s[40:43], s32 offen lds
    s_add_u32 m0, s57, 32768
    s_add_u32 s32, s93, 0
    buffer_load_dwordx4 v11, s[36:39], s32 offen lds
    s_add_u32 m0, s57, 8192
    s_add_u32 s32, s92, 131072
    buffer_load_dwordx4 v10, s[40:43], s32 offen lds
    s_add_u32 m0, s57, 12288
    s_add_u32 s32, s92, 196608
    buffer_load_dwordx4 v8, s[40:43], s32 offen lds
    s_add_u32 m0, s57, 36864
    s_add_u32 s32, s93, 28672
    buffer_load_dwordx4 v11, s[36:39], s32 offen lds
    s_add_u32 m0, s57, 16384
    s_add_u32 s32, s92, 262144
    buffer_load_dwordx4 v10, s[40:43], s32 offen lds
    s_add_u32 m0, s57, 20480
    s_add_u32 s32, s92, 327680
    buffer_load_dwordx4 v8, s[40:43], s32 offen lds
    s_add_u32 m0, s57, 24576
    s_add_u32 s32, s92, 393216
    buffer_load_dwordx4 v10, s[40:43], s32 offen lds
    s_add_u32 m0, s57, 28672
    s_add_u32 s32, s92, 458752
    buffer_load_dwordx4 v8, s[40:43], s32 offen lds
    s_mul_i32 s32, s8, 112
    s_mul_i32 s33, s14, 28
    s_add_u32 s32, s32, s33
    s_lshl_b32 s32, s32, 7
    s_mul_i32 s33, s7, 57344
    s_add_u32 s33, s32, s33
    s_mov_b64 s[34:35], exec
    s_mov_b32 exec_lo, 0xfffffff
    s_mov_b32 exec_hi, 0
    buffer_load_dword v31, v27, s[36:39], s33 offen
    s_mov_b64 exec, s[34:35]
    s_mov_b32 s44, s18
    s_and_b32 s45, s19, 0xffff
    s_mov_b32 s46, 2097152
    s_mov_b32 s47, 0x20000
    s_mov_b32 s48, s20
    s_and_b32 s49, s21, 0xffff
    s_mov_b32 s50, 2097152
    s_mov_b32 s51, 0x20000
    s_mov_b32 s52, s24
    s_and_b32 s53, s25, 0xffff
    s_mov_b32 s54, 3670016
    s_mov_b32 s55, 0x20000
    s_mov_b32 s64, s26
    s_and_b32 s65, s27, 0xffff
    s_mov_b32 s66, 12845056
    s_mov_b32 s67, 0x20000
    s_lshl3_add_u32 s60, s7, s10
    s_lshl_b32 s60, s60, 15
    s_add_u32 s60, s60, s57
    s_lshl_b32 s32, s6, 1
    s_lshl3_add_u32 s61, s7, s32
    s_lshl_b32 s61, s61, 15
    s_mov_b32 s62, s61
    s_lshl_b32 s32, s14, 12
    s_add_u32 s61, s61, s32
    s_mul_i32 s59, s6, 917504
    s_lshl_b32 s32, s8, 8
    s_add_u32 s59, s59, s32
    s_mul_i32 s32, s14, 3584
    s_add_u32 s59, s59, s32
    s_lshl_b32 s32, s14, 1
    v_add_u32 v6, s32, v3
    v_and_b32 v7, 31, v2
    v_xor_b32 v7, v7, v6
    v_lshlrev_b32 v7, 4, v7
    v_lshlrev_b32 v20, 9, v3
    v_add_u32 v12, v7, v20
    v_xor_b32 v13, 128, v12
    v_lshrrev_b32 v6, 4, v2
    s_lshr_b32 s32, s14, 1
    s_lshl_b32 s32, s32, 2
    v_add_u32 v7, s32, v6
    v_and_b32 v20, 15, v2
    v_lshrrev_b32 v20, 1, v20
    v_xor_b32 v7, v7, v20
    v_lshlrev_b32 v7, 5, v7
    v_mul_u32_u24 v6, 896, v6
    v_add_u32 v7, v7, v6
    v_add_u32 v15, v7, v5
    v_lshlrev_b32 v16, 4, v2
    v_add_u32 v17, s57, v16
    v_mov_b32 v22, 0
    v_mov_b32 v24, 0
    v_mov_b32 v25, 0
    s_lshl2_add_u32 s32, s15, s6
    s_lshl2_add_u32 s32, s32, s14
    s_lshl_b32 s32, s32, 9
    s_add_u32 s32, s32, 12582912
    s_add_u32 s68, s26, s32
    s_addc_u32 s69, s27, 0
    s_mov_b32 s72, 0
    s_mov_b32 s73, 0
    s_lshl_b32 s92, s90, 19
    s_add_u32 s92, s92, s58
    s_lshl_b32 s93, s90, 7
    s_add_u32 s93, s93, s56
    s_mov_b32 s90, s96
    s_add_u32 m0, s57, 40960
    s_add_u32 s32, s92, 0
    buffer_load_dwordx4 v10, s[40:43], s32 offen lds
    s_add_u32 m0, s57, 45056
    s_add_u32 s32, s92, 65536
    buffer_load_dwordx4 v8, s[40:43], s32 offen lds
    s_add_u32 m0, s57, 73728
    s_add_u32 s32, s93, 0
    buffer_load_dwordx4 v11, s[36:39], s32 offen lds
    s_add_u32 m0, s57, 49152
    s_add_u32 s32, s92, 131072
    buffer_load_dwordx4 v10, s[40:43], s32 offen lds
    s_add_u32 m0, s57, 53248
    s_add_u32 s32, s92, 196608
    buffer_load_dwordx4 v8, s[40:43], s32 offen lds
    s_add_u32 m0, s57, 77824
    s_add_u32 s32, s93, 28672
    buffer_load_dwordx4 v11, s[36:39], s32 offen lds
    s_add_u32 m0, s57, 57344
    s_add_u32 s32, s92, 262144
    buffer_load_dwordx4 v10, s[40:43], s32 offen lds
    s_add_u32 m0, s57, 61440
    s_add_u32 s32, s92, 327680
    buffer_load_dwordx4 v8, s[40:43], s32 offen lds
    s_add_u32 m0, s57, 65536
    s_add_u32 s32, s92, 393216
    buffer_load_dwordx4 v10, s[40:43], s32 offen lds
    s_add_u32 m0, s57, 69632
    s_add_u32 s32, s92, 458752
    buffer_load_dwordx4 v8, s[40:43], s32 offen lds
    s_lshl_b32 s92, s90, 19
    s_add_u32 s92, s92, s58
    s_lshl_b32 s93, s90, 7
    s_add_u32 s93, s93, s56
    s_add_u32 s90, s90, 1
    s_cmp_ge_u32 s90, 7
    s_cselect_b32 s90, 2, s90
    s_add_u32 m0, s57, 81920
    s_add_u32 s32, s92, 0
    buffer_load_dwordx4 v10, s[40:43], s32 offen lds
    s_add_u32 m0, s57, 86016
    s_add_u32 s32, s92, 65536
    buffer_load_dwordx4 v8, s[40:43], s32 offen lds
    s_or_b32 s32, s2, s14
    s_cmp_lg_u32 s32, 0
    s_cbranch_scc1 L_nononce
    s_memrealtime s[32:33]
    s_waitcnt lgkmcnt(0)
    s_or_b32 s32, s32, 1
    v_mov_b32 v20, s32
    v_mov_b32 v21, s33
    s_mov_b64 s[34:35], exec
    s_mov_b64 exec, 1
    global_store_dwordx2 v22, v[20:21], s[30:31] sc1
    s_mov_b64 exec, s[34:35]
L_nononce:
    s_waitcnt vmcnt(13)
    s_barrier
    s_add_u32 m0, s57, 114688
    s_add_u32 s32, s93, 0
    buffer_load_dwordx4 v11, s[36:39], s32 offen lds
    s_add_u32 m0, s57, 90112
    s_add_u32 s32, s92, 131072
    buffer_load_dwordx4 v10, s[40:43], s32 offen lds
    s_add_u32 m0, s57, 94208
    s_add_u32 s32, s92, 196608
    buffer_load_dwordx4 v8, s[40:43], s32 offen lds
    s_add_u32 m0, s57, 118784
    s_add_u32 s32, s93, 28672
    buffer_load_dwordx4 v11, s[36:39], s32 offen lds
    s_add_u32 m0, s57, 98304
    s_add_u32 s32, s92, 262144
    buffer_load_dwordx4 v10, s[40:43], s32 offen lds
    s_add_u32 m0, s57, 102400
    s_add_u32 s32, s92, 327680
    buffer_load_dwordx4 v8, s[40:43], s32 offen lds
    s_add_u32 m0, s57, 106496
    s_add_u32 s32, s92, 393216
    buffer_load_dwordx4 v10, s[40:43], s32 offen lds
    s_add_u32 m0, s57, 110592
    s_add_u32 s32, s92, 458752
    buffer_load_dwordx4 v8, s[40:43], s32 offen lds
    s_lshl_b32 s92, s90, 19
    s_add_u32 s92, s92, s58
    s_lshl_b32 s93, s90, 7
    s_add_u32 s93, s93, s56
    s_add_u32 s90, s90, 1
    s_cmp_ge_u32 s90, 7
    s_cselect_b32 s90, 2, s90
    s_add_u32 m0, s57, 122880
    s_add_u32 s32, s92, 0
    buffer_load_dwordx4 v10, s[40:43], s32 offen lds
    s_add_u32 m0, s57, 126976
    s_add_u32 s32, s92, 65536
    buffer_load_dwordx4 v8, s[40:43], s32 offen lds
    s_waitcnt vmcnt(12)
    s_barrier
    s_add_u32 m0, s57, 155648
    s_add_u32 s32, s93, 0
    buffer_load_dwordx4 v11, s[36:39], s32 offen lds
    s_add_u32 m0, s57, 131072
    s_add_u32 s32, s92, 131072
    buffer_load_dwordx4 v10, s[40:43], s32 offen lds
    s_add_u32 m0, s57, 135168
    s_add_u32 s32, s92, 196608
    buffer_load_dwordx4 v8, s[40:43], s32 offen lds
    s_add_u32 m0, s57, 159744
    s_add_u32 s32, s93, 28672
    buffer_load_dwordx4 v11, s[36:39], s32 offen lds
    s_add_u32 m0, s57, 139264
    s_add_u32 s32, s92, 262144
    buffer_load_dwordx4 v10, s[40:43], s32 offen lds
    s_add_u32 m0, s57, 143360
    s_add_u32 s32, s92, 327680
    buffer_load_dwordx4 v8, s[40:43], s32 offen lds
    s_add_u32 m0, s57, 147456
    s_add_u32 s32, s92, 393216
    buffer_load_dwordx4 v10, s[40:43], s32 offen lds
    s_add_u32 m0, s57, 151552
    s_add_u32 s32, s92, 458752
    buffer_load_dwordx4 v8, s[40:43], s32 offen lds
    s_lshl_b32 s92, s90, 19
    s_add_u32 s92, s92, s58
    s_lshl_b32 s93, s90, 7
    s_add_u32 s93, s93, s56
    s_add_u32 s90, s90, 1
    s_cmp_ge_u32 s90, 7
    s_cselect_b32 s90, 2, s90
    s_add_u32 m0, s57, 0
    s_add_u32 s32, s92, 0
    buffer_load_dwordx4 v10, s[40:43], s32 offen lds
    s_add_u32 m0, s57, 4096
    s_add_u32 s32, s92, 65536
    buffer_load_dwordx4 v8, s[40:43], s32 offen lds
    s_waitcnt vmcnt(12)
    s_barrier
    s_add_u32 m0, s57, 32768
    s_add_u32 s32, s93, 0
    buffer_load_dwordx4 v11, s[36:39], s32 offen lds
    s_add_u32 m0, s57, 8192
    s_add_u32 s32, s92, 131072
    buffer_load_dwordx4 v10, s[40:43], s32 offen lds
    s_add_u32 m0, s57, 12288
    s_add_u32 s32, s92, 196608
    buffer_load_dwordx4 v8, s[40:43], s32 offen lds
    s_add_u32 m0, s57, 36864
    s_add_u32 s32, s93, 28672
    buffer_load_dwordx4 v11, s[36:39], s32 offen lds
    s_add_u32 m0, s57, 16384
    s_add_u32 s32, s92, 262144
    buffer_load_dwordx4 v10, s[40:43], s32 offen lds
    s_add_u32 m0, s57, 20480
    s_add_u32 s32, s92, 327680
    buffer_load_dwordx4 v8, s[40:43], s32 offen lds
    s_add_u32 m0, s57, 24576
    s_add_u32 s32, s92, 393216
    buffer_load_dwordx4 v10, s[40:43], s32 offen lds
    s_add_u32 m0, s57, 28672
    s_add_u32 s32, s92, 458752
    buffer_load_dwordx4 v8, s[40:43], s32 offen lds
    s_lshl_b32 s92, s90, 19
    s_add_u32 s92, s92, s58
    s_lshl_b32 s93, s90, 7
    s_add_u32 s93, s93, s56
    s_add_u32 s90, s90, 1
    s_cmp_ge_u32 s90, 7
    s_cselect_b32 s90, 2, s90
    s_add_u32 m0, s57, 40960
    s_add_u32 s32, s92, 0
    buffer_load_dwordx4 v10, s[40:43], s32 offen lds
    s_add_u32 m0, s57, 45056
    s_add_u32 s32, s92, 65536
    buffer_load_dwordx4 v8, s[40:43], s32 offen lds
    s_waitcnt vmcnt(12)
    s_barrier
    s_add_u32 m0, s57, 73728
    s_add_u32 s32, s93, 0
    buffer_load_dwordx4 v11, s[36:39], s32 offen lds
    s_add_u32 m0, s57, 49152
    s_add_u32 s32, s92, 131072
    buffer_load_dwordx4 v10, s[40:43], s32 offen lds
    s_add_u32 m0, s57, 53248
    s_add_u32 s32, s92, 196608
    buffer_load_dwordx4 v8, s[40:43], s32 offen lds
    s_add_u32 m0, s57, 77824
    s_add_u32 s32, s93, 28672
    buffer_load_dwordx4 v11, s[36:39], s32 offen lds
    s_add_u32 m0, s57, 57344
    s_add_u32 s32, s92, 262144
    buffer_load_dwordx4 v10, s[40:43], s32 offen lds
    s_add_u32 m0, s57, 61440
    s_add_u32 s32, s92, 327680
    buffer_load_dwordx4 v8, s[40:43], s32 offen lds
    s_add_u32 m0, s57, 65536
    s_add_u32 s32, s92, 393216
    buffer_load_dwordx4 v10, s[40:43], s32 offen lds
    s_add_u32 m0, s57, 69632
    s_add_u32 s32, s92, 458752
    buffer_load_dwordx4 v8, s[40:43], s32 offen lds
    s_lshl_b32 s92, s90, 19
    s_add_u32 s92, s92, s58
    s_lshl_b32 s93, s90, 7
    s_add_u32 s93, s93, s56
    s_add_u32 s90, s90, 1
    s_cmp_ge_u32 s90, 7
    s_cselect_b32 s90, 2, s90
    s_add_u32 m0, s57, 81920
    s_add_u32 s32, s92, 0
    buffer_load_dwordx4 v10, s[40:43], s32 offen lds
    s_add_u32 m0, s57, 86016
    s_add_u32 s32, s92, 65536
    buffer_load_dwordx4 v8, s[40:43], s32 offen lds
    s_waitcnt vmcnt(12)
    s_barrier
    s_add_u32 m0, s57, 114688
    s_add_u32 s32, s93, 0
    buffer_load_dwordx4 v11, s[36:39], s32 offen lds
    s_add_u32 m0, s57, 90112
    s_add_u32 s32, s92, 131072
    buffer_load_dwordx4 v10, s[40:43], s32 offen lds
    s_add_u32 m0, s57, 94208
    s_add_u32 s32, s92, 196608
    buffer_load_dwordx4 v8, s[40:43], s32 offen lds
    s_add_u32 m0, s57, 118784
    s_add_u32 s32, s93, 28672
    buffer_load_dwordx4 v11, s[36:39], s32 offen lds
    s_add_u32 m0, s57, 98304
    s_add_u32 s32, s92, 262144
    buffer_load_dwordx4 v10, s[40:43], s32 offen lds
    s_add_u32 m0, s57, 102400
    s_add_u32 s32, s92, 327680
    buffer_load_dwordx4 v8, s[40:43], s32 offen lds
    s_add_u32 m0, s57, 106496
    s_add_u32 s32, s92, 393216
    buffer_load_dwordx4 v10, s[40:43], s32 offen lds
    s_add_u32 m0, s57, 110592
    s_add_u32 s32, s92, 458752
    buffer_load_dwordx4 v8, s[40:43], s32 offen lds
    s_add_u32 m0, s57, 122880
    s_add_u32 s32, s60, 0
    buffer_load_dwordx4 v12, s[44:47], s32 offen lds
    s_add_u32 m0, s57, 126976
    s_add_u32 s32, s60, 4096
    buffer_load_dwordx4 v13, s[44:47], s32 offen lds
    s_waitcnt vmcnt(12)
    s_barrier
    s_add_u32 m0, s57, 131072
    s_add_u32 s32, s60, 8192
    buffer_load_dwordx4 v12, s[44:47], s32 offen lds
    s_add_u32 m0, s57, 135168
    s_add_u32 s32, s60, 12288
    buffer_load_dwordx4 v13, s[44:47], s32 offen lds
    s_add_u32 m0, s57, 139264
    s_add_u32 s32, s60, 16384
    buffer_load_dwordx4 v12, s[44:47], s32 offen lds
    s_add_u32 m0, s57, 143360
    s_add_u32 s32, s60, 20480
    buffer_load_dwordx4 v13, s[44:47], s32 offen lds
    s_add_u32 m0, s57, 147456
    s_add_u32 s32, s60, 24576
    buffer_load_dwordx4 v12, s[44:47], s32 offen lds
    s_add_u32 m0, s57, 151552
    s_add_u32 s32, s60, 28672
    buffer_load_dwordx4 v13, s[44:47], s32 offen lds
    s_add_u32 s91, s95, 0
    s_and_b32 s91, s91, 3
    s_xor_b32 s89, s94, 0
    s_mul_i32 s92, s89, 458752
    s_mul_i32 s88, s91, 57344
    s_add_u32 s92, s92, s88
    s_add_u32 s92, s92, s59
    s_lshl_b32 s93, s89, 15
    s_lshl_b32 s88, s91, 7
    s_add_u32 s93, s93, s88
    s_add_u32 s93, s93, s61
    s_add_u32 m0, s57, 0
    s_add_u32 s32, s92, 0
    buffer_load_dwordx4 v15, s[52:55], s32 offen lds
    s_add_u32 m0, s57, 4096
    s_add_u32 s32, s92, 14336
    buffer_load_dwordx4 v15, s[52:55], s32 offen lds
    s_add_u32 m0, s57, 32768
    s_add_u32 s32, s93, 0
    buffer_load_dwordx4 v14, s[48:51], s32 offen lds
    s_add_u32 m0, s57, 8192
    s_add_u32 s32, s92, 28672
    buffer_load_dwordx4 v15, s[52:55], s32 offen lds
    s_waitcnt vmcnt(12)
    s_barrier
    s_add_u32 m0, s57, 12288
    s_add_u32 s32, s92, 43008
    buffer_load_dwordx4 v15, s[52:55], s32 offen lds
    s_add_u32 m0, s57, 36864
    s_add_u32 s32, s93, 16384
    buffer_load_dwordx4 v14, s[48:51], s32 offen lds
    s_add_u32 m0, s57, 16384
    s_add_u32 s32, s92, 229376
    buffer_load_dwordx4 v15, s[52:55], s32 offen lds
    s_add_u32 m0, s57, 20480
    s_add_u32 s32, s92, 243712
    buffer_load_dwordx4 v15, s[52:55], s32 offen lds
    s_add_u32 m0, s57, 24576
    s_add_u32 s32, s92, 258048
    buffer_load_dwordx4 v15, s[52:55], s32 offen lds
    s_add_u32 m0, s57, 28672
    s_add_u32 s32, s92, 272384
    buffer_load_dwordx4 v15, s[52:55], s32 offen lds
    s_lshl_b32 s32, s8, 14
    s_add_u32 s33, s62, s32
    s_lshl_b32 s32, s14, 12
    s_add_u32 s33, s33, s32
    s_mov_b64 s[34:35], exec
    s_mov_b32 exec_lo, 0xffffffff
    s_mov_b32 exec_hi, 0
    buffer_load_dword v31, v27, s[48:51], s33 offen
    s_mov_b64 exec, s[34:35]
    global_load_dwordx2 v[24:25], v22, s[30:31]
    s_waitcnt vmcnt(12)
    s_barrier
    s_add_u32 s91, s95, 1
    s_and_b32 s91, s91, 3
    s_xor_b32 s89, s94, 0
    s_mul_i32 s92, s89, 458752
    s_mul_i32 s88, s91, 57344
    s_add_u32 s92, s92, s88
    s_add_u32 s92, s92, s59
    s_lshl_b32 s93, s89, 15
    s_lshl_b32 s88, s91, 7
    s_add_u32 s93, s93, s88
    s_add_u32 s93, s93, s61
    s_add_u32 m0, s57, 81920
    s_add_u32 s32, s92, 0
    buffer_load_dwordx4 v15, s[52:55], s32 offen lds
    s_add_u32 m0, s57, 86016
    s_add_u32 s32, s92, 14336
    buffer_load_dwordx4 v15, s[52:55], s32 offen lds
    s_add_u32 m0, s57, 114688
    s_add_u32 s32, s93, 0
    buffer_load_dwordx4 v14, s[48:51], s32 offen lds
    s_add_u32 m0, s57, 90112
    s_add_u32 s32, s92, 28672
    buffer_load_dwordx4 v15, s[52:55], s32 offen lds
    s_add_u32 m0, s57, 94208
    s_add_u32 s32, s92, 43008
    buffer_load_dwordx4 v15, s[52:55], s32 offen lds
    s_add_u32 m0, s57, 118784
    s_add_u32 s32, s93, 16384
    buffer_load_dwordx4 v14, s[48:51], s32 offen lds
    s_add_u32 m0, s57, 98304
    s_add_u32 s32, s92, 229376
    buffer_load_dwordx4 v15, s[52:55], s32 offen lds
    s_add_u32 m0, s57, 102400
    s_add_u32 s32, s92, 243712
    buffer_load_dwordx4 v15, s[52:55], s32 offen lds
    s_add_u32 m0, s57, 106496
    s_add_u32 s32, s92, 258048
    buffer_load_dwordx4 v15, s[52:55], s32 offen lds
    s_add_u32 m0, s57, 110592
    s_add_u32 s32, s92, 272384
    buffer_load_dwordx4 v15, s[52:55], s32 offen lds
    s_waitcnt vmcnt(12)
    s_barrier
    s_add_u32 s91, s95, 2
    s_and_b32 s91, s91, 3
    s_xor_b32 s89, s94, 0
    s_mul_i32 s92, s89, 458752
    s_mul_i32 s88, s91, 57344
    s_add_u32 s92, s92, s88
    s_add_u32 s92, s92, s59
    s_lshl_b32 s93, s89, 15
    s_lshl_b32 s88, s91, 7
    s_add_u32 s93, s93, s88
    s_add_u32 s93, s93, s61
    s_add_u32 m0, s57, 122880
    s_add_u32 s32, s92, 0
    buffer_load_dwordx4 v15, s[52:55], s32 offen lds
    s_add_u32 m0, s57, 126976
    s_add_u32 s32, s92, 14336
    buffer_load_dwordx4 v15, s[52:55], s32 offen lds
    s_add_u32 m0, s57, 155648
    s_add_u32 s32, s93, 0
    buffer_load_dwordx4 v14, s[48:51], s32 offen lds
    s_add_u32 m0, s57, 131072
    s_add_u32 s32, s92, 28672
    buffer_load_dwordx4 v15, s[52:55], s32 offen lds
    s_add_u32 m0, s57, 135168
    s_add_u32 s32, s92, 43008
    buffer_load_dwordx4 v15, s[52:55], s32 offen lds
    s_add_u32 m0, s57, 159744
    s_add_u32 s32, s93, 16384
    buffer_load_dwordx4 v14, s[48:51], s32 offen lds
    s_add_u32 m0, s57, 139264
    s_add_u32 s32, s92, 229376
    buffer_load_dwordx4 v15, s[52:55], s32 offen lds
    s_add_u32 m0, s57, 143360
    s_add_u32 s32, s92, 243712
    buffer_load_dwordx4 v15, s[52:55], s32 offen lds
    s_add_u32 m0, s57, 147456
    s_add_u32 s32, s92, 258048
    buffer_load_dwordx4 v15, s[52:55], s32 offen lds
    s_add_u32 m0, s57, 151552
    s_add_u32 s32, s92, 272384
    buffer_load_dwordx4 v15, s[52:55], s32 offen lds
    s_add_u32 s91, s95, 3
    s_and_b32 s91, s91, 3
    s_xor_b32 s89, s94, 0
    s_mul_i32 s92, s89, 458752
    s_mul_i32 s88, s91, 57344
    s_add_u32 s92, s92, s88
    s_add_u32 s92, s92, s59
    s_lshl_b32 s93, s89, 15
    s_lshl_b32 s88, s91, 7
    s_add_u32 s93, s93, s88
    s_add_u32 s93, s93, s61
    s_add_u32 m0, s57, 40960
    s_add_u32 s32, s92, 0
    buffer_load_dwordx4 v15, s[52:55], s32 offen lds
    s_add_u32 m0, s57, 45056
    s_add_u32 s32, s92, 14336
    buffer_load_dwordx4 v15, s[52:55], s32 offen lds
    s_waitcnt vmcnt(12)
    s_barrier
    s_add_u32 m0, s57, 73728
    s_add_u32 s32, s93, 0
    buffer_load_dwordx4 v14, s[48:51], s32 offen lds
    s_add_u32 m0, s57, 49152
    s_add_u32 s32, s92, 28672
    buffer_load_dwordx4 v15, s[52:55], s32 offen lds
    s_add_u32 m0, s57, 53248
    s_add_u32 s32, s92, 43008
    buffer_load_dwordx4 v15, s[52:55], s32 offen lds
    s_add_u32 m0, s57, 77824
    s_add_u32 s32, s93, 16384
    buffer_load_dwordx4 v14, s[48:51], s32 offen lds
    s_add_u32 m0, s57, 57344
    s_add_u32 s32, s92, 229376
    buffer_load_dwordx4 v15, s[52:55], s32 offen lds
    s_add_u32 m0, s57, 61440
    s_add_u32 s32, s92, 243712
    buffer_load_dwordx4 v15, s[52:55], s32 offen lds
    s_add_u32 m0, s57, 65536
    s_add_u32 s32, s92, 258048
    buffer_load_dwordx4 v15, s[52:55], s32 offen lds
    s_add_u32 m0, s57, 69632
    s_add_u32 s32, s92, 272384
    buffer_load_dwordx4 v15, s[52:55], s32 offen lds
    s_add_u32 s91, s95, 4
    s_and_b32 s91, s91, 3
    s_xor_b32 s89, s94, 1
    s_mul_i32 s92, s89, 458752
    s_mul_i32 s88, s91, 57344
    s_add_u32 s92, s92, s88
    s_add_u32 s92, s92, s59
    s_lshl_b32 s93, s89, 15
    s_lshl_b32 s88, s91, 7
    s_add_u32 s93, s93, s88
    s_add_u32 s93, s93, s61
    s_add_u32 m0, s57, 0
    s_add_u32 s32, s92, 0
    buffer_load_dwordx4 v15, s[52:55], s32 offen lds
    s_add_u32 m0, s57, 4096
    s_add_u32 s32, s92, 14336
    buffer_load_dwordx4 v15, s[52:55], s32 offen lds
    s_waitcnt vmcnt(12)
    s_barrier
    s_add_u32 m0, s57, 32768
    s_add_u32 s32, s93, 0
    buffer_load_dwordx4 v14, s[48:51], s32 offen lds
    s_add_u32 m0, s57, 8192
    s_add_u32 s32, s92, 28672
    buffer_load_dwordx4 v15, s[52:55], s32 offen lds
    s_add_u32 m0, s57, 12288
    s_add_u32 s32, s92, 43008
    buffer_load_dwordx4 v15, s[52:55], s32 offen lds
    s_add_u32 m0, s57, 36864
    s_add_u32 s32, s93, 16384
    buffer_load_dwordx4 v14, s[48:51], s32 offen lds
    s_add_u32 m0, s57, 16384
    s_add_u32 s32, s92, 229376
    buffer_load_dwordx4 v15, s[52:55], s32 offen lds
    s_add_u32 m0, s57, 20480
    s_add_u32 s32, s92, 243712
    buffer_load_dwordx4 v15, s[52:55], s32 offen lds
    s_add_u32 m0, s57, 24576
    s_add_u32 s32, s92, 258048
    buffer_load_dwordx4 v15, s[52:55], s32 offen lds
    s_add_u32 m0, s57, 28672
    s_add_u32 s32, s92, 272384
    buffer_load_dwordx4 v15, s[52:55], s32 offen lds
    s_add_u32 s91, s95, 5
    s_and_b32 s91, s91, 3
    s_xor_b32 s89, s94, 1
    s_mul_i32 s92, s89, 458752
    s_mul_i32 s88, s91, 57344
    s_add_u32 s92, s92, s88
    s_add_u32 s92, s92, s59
    s_lshl_b32 s93, s89, 15
    s_lshl_b32 s88, s91, 7
    s_add_u32 s93, s93, s88
    s_add_u32 s93, s93, s61
    s_add_u32 m0, s57, 81920
    s_add_u32 s32, s92, 0
    buffer_load_dwordx4 v15, s[52:55], s32 offen lds
    s_add_u32 m0, s57, 86016
    s_add_u32 s32, s92, 14336
    buffer_load_dwordx4 v15, s[52:55], s32 offen lds
L_gn_1:
    v_readfirstlane_b32 s72, v24
    v_readfirstlane_b32 s73, v25
    s_or_b32 s32, s72, s73
    s_cmp_lg_u32 s32, 0
    s_cbranch_scc1 L_hn_1
    s_sleep 4
    global_load_dwordx2 v[24:25], v22, s[30:31] sc1
    s_waitcnt vmcnt(0)
    s_branch L_gn_1
L_hn_1:
    s_waitcnt vmcnt(12)
    s_barrier
    s_add_u32 m0, s57, 114688
    s_add_u32 s32, s93, 0
    buffer_load_dwordx4 v14, s[48:51], s32 offen lds
    s_add_u32 m0, s57, 90112
    s_add_u32 s32, s92, 28672
    buffer_load_dwordx4 v15, s[52:55], s32 offen lds
    s_add_u32 m0, s57, 94208
    s_add_u32 s32, s92, 43008
    buffer_load_dwordx4 v15, s[52:55], s32 offen lds
    s_add_u32 m0, s57, 118784
    s_add_u32 s32, s93, 16384
    buffer_load_dwordx4 v14, s[48:51], s32 offen lds
    s_add_u32 m0, s57, 98304
    s_add_u32 s32, s92, 229376
    buffer_load_dwordx4 v15, s[52:55], s32 offen lds
    s_add_u32 m0, s57, 102400
    s_add_u32 s32, s92, 243712
    buffer_load_dwordx4 v15, s[52:55], s32 offen lds
    s_add_u32 m0, s57, 106496
    s_add_u32 s32, s92, 258048
    buffer_load_dwordx4 v15, s[52:55], s32 offen lds
    s_add_u32 m0, s57, 110592
    s_add_u32 s32, s92, 272384
    buffer_load_dwordx4 v15, s[52:55], s32 offen lds
    s_add_u32 s91, s95, 6
    s_and_b32 s91, s91, 3
    s_xor_b32 s89, s94, 1
    s_mul_i32 s92, s89, 458752
    s_mul_i32 s88, s91, 57344
    s_add_u32 s92, s92, s88
    s_add_u32 s92, s92, s59
    s_lshl_b32 s93, s89, 15
    s_lshl_b32 s88, s91, 7
    s_add_u32 s93, s93, s88
    s_add_u32 s93, s93, s61
    s_add_u32 m0, s57, 122880
    s_add_u32 s32, s92, 0
    buffer_load_dwordx4 v15, s[52:55], s32 offen lds
    s_add_u32 m0, s57, 126976
    s_add_u32 s32, s92, 14336
    buffer_load_dwordx4 v15, s[52:55], s32 offen lds
    s_waitcnt vmcnt(12)
    s_load_dwordx2 s[80:81], s[68:69], 0x0 glc
    s_load_dwordx2 s[82:83], s[68:69], 0x80 glc
    s_load_dwordx2 s[84:85], s[68:69], 0x100 glc
    s_load_dwordx2 s[86:87], s[68:69], 0x180 glc
    s_barrier
    s_add_u32 m0, s57, 155648
    s_add_u32 s32, s93, 0
    buffer_load_dwordx4 v14, s[48:51], s32 offen lds
    s_add_u32 m0, s57, 131072
    s_add_u32 s32, s92, 28672
    buffer_load_dwordx4 v15, s[52:55], s32 offen lds
    s_add_u32 m0, s57, 135168
    s_add_u32 s32, s92, 43008
    buffer_load_dwordx4 v15, s[52:55], s32 offen lds
    s_add_u32 m0, s57, 159744
    s_add_u32 s32, s93, 16384
    buffer_load_dwordx4 v14, s[48:51], s32 offen lds
    s_add_u32 m0, s57, 139264
    s_add_u32 s32, s92, 229376
    buffer_load_dwordx4 v15, s[52:55], s32 offen lds
    s_add_u32 m0, s57, 143360
    s_add_u32 s32, s92, 243712
    buffer_load_dwordx4 v15, s[52:55], s32 offen lds
    s_add_u32 m0, s57, 147456
    s_add_u32 s32, s92, 258048
    buffer_load_dwordx4 v15, s[52:55], s32 offen lds
    s_add_u32 m0, s57, 151552
    s_add_u32 s32, s92, 272384
    buffer_load_dwordx4 v15, s[52:55], s32 offen lds
    s_add_u32 s91, s95, 7
    s_and_b32 s91, s91, 3
    s_xor_b32 s89, s94, 1
    s_mul_i32 s92, s89, 458752
    s_mul_i32 s88, s91, 57344
    s_add_u32 s92, s92, s88
    s_add_u32 s92, s92, s59
    s_lshl_b32 s93, s89, 15
    s_lshl_b32 s88, s91, 7
    s_add_u32 s93, s93, s88
    s_add_u32 s93, s93, s61
    s_add_u32 m0, s57, 40960
    s_add_u32 s32, s92, 0
    buffer_load_dwordx4 v15, s[52:55], s32 offen lds
    s_add_u32 m0, s57, 45056
    s_add_u32 s32, s92, 14336
    buffer_load_dwordx4 v15, s[52:55], s32 offen lds
    s_waitcnt vmcnt(12)
    s_barrier
    s_add_u32 m0, s57, 73728
    s_add_u32 s32, s93, 0
    buffer_load_dwordx4 v14, s[48:51], s32 offen lds
    s_add_u32 m0, s57, 49152
    s_add_u32 s32, s92, 28672
    buffer_load_dwordx4 v15, s[52:55], s32 offen lds
    s_add_u32 m0, s57, 53248
    s_add_u32 s32, s92, 43008
    buffer_load_dwordx4 v15, s[52:55], s32 offen lds
    s_add_u32 m0, s57, 77824
    s_add_u32 s32, s93, 16384
    buffer_load_dwordx4 v14, s[48:51], s32 offen lds
    s_add_u32 m0, s57, 57344
    s_add_u32 s32, s92, 229376
    buffer_load_dwordx4 v15, s[52:55], s32 offen lds
    s_add_u32 m0, s57, 61440
    s_add_u32 s32, s92, 243712
    buffer_load_dwordx4 v15, s[52:55], s32 offen lds
    s_add_u32 m0, s57, 65536
    s_add_u32 s32, s92, 258048
    buffer_load_dwordx4 v15, s[52:55], s32 offen lds
    s_add_u32 m0, s57, 69632
    s_add_u32 s32, s92, 272384
    buffer_load_dwordx4 v15, s[52:55], s32 offen lds
L_sp_2:
    s_waitcnt lgkmcnt(0)
    s_cmp_eq_u64 s[80:81], s[72:73]
    s_cbranch_scc0 L_sr_2
    s_cmp_eq_u64 s[82:83], s[72:73]
    s_cbranch_scc0 L_sr_2
    s_cmp_eq_u64 s[84:85], s[72:73]
    s_cbranch_scc0 L_sr_2
    s_cmp_eq_u64 s[86:87], s[72:73]
    s_cbranch_scc0 L_sr_2
    s_branch L_so_2
L_sr_2:
    s_sleep 2
    s_load_dwordx2 s[80:81], s[68:69], 0x0 glc
    s_load_dwordx2 s[82:83], s[68:69], 0x80 glc
    s_load_dwordx2 s[84:85], s[68:69], 0x100 glc
    s_load_dwordx2 s[86:87], s[68:69], 0x180 glc
    s_branch L_sp_2
L_so_2:
    s_lshl2_add_u32 s33, s15, s6
    s_lshl_b32 s33, s33, 15
    s_lshl_b32 s34, s14, 11
    s_add_u32 s33, s33, s34
    s_add_u32 m0, s34, 0
    s_add_u32 s32, s33, 0
    buffer_load_dwordx4 v16, s[64:67], s32 offen sc1 lds
    s_add_u32 m0, s34, 1024
    s_add_u32 s32, s33, 1024
    buffer_load_dwordx4 v16, s[64:67], s32 offen sc1 lds
    s_add_u32 m0, s34, 8192
    s_add_u32 s32, s33, 8192
    buffer_load_dwordx4 v16, s[64:67], s32 offen sc1 lds
    s_add_u32 m0, s34, 9216
    s_add_u32 s32, s33, 9216
    buffer_load_dwordx4 v16, s[64:67], s32 offen sc1 lds
    s_add_u32 m0, s34, 16384
    s_add_u32 s32, s33, 16384
    buffer_load_dwordx4 v16, s[64:67], s32 offen sc1 lds
    s_add_u32 m0, s34, 17408
    s_add_u32 s32, s33, 17408
    buffer_load_dwordx4 v16, s[64:67], s32 offen sc1 lds
    s_add_u32 m0, s34, 24576
    s_add_u32 s32, s33, 24576
    buffer_load_dwordx4 v16, s[64:67], s32 offen sc1 lds
    s_add_u32 m0, s34, 25600
    s_add_u32 s32, s33, 25600
    buffer_load_dwordx4 v16, s[64:67], s32 offen sc1 lds
    s_waitcnt vmcnt(18)
    s_barrier
    s_waitcnt vmcnt(8)
    s_barrier
    s_waitcnt vmcnt(0)
    s_barrier
L_done:
    s_endpgm

.section .rodata,"a"
.p2align 6
.amdhsa_kernel concat_heads__gqa_block_cached__gqa_block_cached__near_ridge_kernel
  .amdhsa_next_free_vgpr 256
  .amdhsa_next_free_sgpr 102
  .amdhsa_accum_offset 256
  .amdhsa_group_segment_fixed_size 0
  .amdhsa_kernarg_size 104
  .amdhsa_user_sgpr_count 2
  .amdhsa_user_sgpr_kernarg_segment_ptr 1
  .amdhsa_system_sgpr_workgroup_id_x 1
.end_amdhsa_kernel
```
